```python
import torch

def _softmax(x, axis=-1):
    return torch.softmax(x, dim=axis)

def _gelu(x):
    return torch.nn.functional.gelu(x, approximate='tanh')

def _silu(x):
    return torch.nn.functional.silu(x)

def _sigmoid(x):
    return torch.sigmoid(x)

def _layernorm(x, axis=-1, eps=1e-05):
    m = x.mean(dim=axis, keepdim=True)
    v = x.var(dim=axis, keepdim=True, unbiased=False)
    return (x - m) / torch.sqrt(v + eps)

def _scatter_add(tgt, idx, src, axis=0):
    return tgt.clone().index_add_(axis, idx, src)

def _segment_sum(src, seg, n):
    out = torch.zeros((n,) + src.shape[1:], dtype=src.dtype)
    return out.index_add_(0, seg, src)

def _pad(x, pw):
    flat = tuple((v for pair in reversed(pw) for v in pair))
    return torch.nn.functional.pad(x, flat)
kernel_name = 'adaLN_cond__spectral_gfnet__moe_arch_mod__prompt'

def setup_inputs():

    _w = lambda a: (lambda t: t.to(torch.bfloat16) if t.is_floating_point() else t)(torch.as_tensor(a))

    def _A_setup():
        B, S, D = (1, 2048, 640)
        Df = D // 2 + 1
        return {'x': _w((lambda *s: torch.randn(*s, dtype=torch.bfloat16) * 0.05)(B, S, D)), 'w_r': _w((lambda *s: torch.randn(*s, dtype=torch.bfloat16) * 3.2)(S, Df) * 0.02), 'w_i': _w((lambda *s: torch.randn(*s, dtype=torch.bfloat16) * 3.2)(S, Df) * 0.02)}
    _A_in = _A_setup()

    def _B_setup():
        B, S, D, F, C = (1, 2048, 640, 1536, 1)
        return {'x': _w((lambda *s: torch.randn(*s, dtype=torch.bfloat16) * 0.05)(B, S, D)), 'w_r': _w((lambda *s: torch.randn(*s, dtype=torch.bfloat16) * 0.05)(D)), 'w_gate': _w((lambda *s: torch.randn(*s, dtype=torch.bfloat16) * 0.05)(D, F)), 'w_up': _w((lambda *s: torch.randn(*s, dtype=torch.bfloat16) * 0.05)(D, F)), 'w_down': _w((lambda *s: torch.randn(*s, dtype=torch.bfloat16) * 0.05)(F, D))}
    _B_in = _B_setup()
    return {'A_x': _A_in['x'], 'A_w_r': _A_in['w_r'], 'A_w_i': _A_in['w_i'], 'B_x': _B_in['x'], 'B_w_r': _B_in['w_r'], 'B_w_gate': _B_in['w_gate'], 'B_w_up': _B_in['w_up'], 'B_w_down': _B_in['w_down'], 'c': _w((lambda *s: torch.randn(*s, dtype=torch.bfloat16) * 0.1)(1, 640) * 8.0), 'w_mod': _w((lambda *s: torch.randn(*s, dtype=torch.bfloat16) * 0.1)(640, 6 * 640) * 640 ** (-0.5) * 8.0)}

def reference(A_x, A_w_r, A_w_i, B_x, B_w_r, B_w_gate, B_w_up, B_w_down, c, w_mod):

    def _A_ref(x, w_r, w_i):
        B, S, D = x.shape
        X = (lambda x, axes=(-2, -1): torch.fft.rfft2(x.float(), dim=axes))(x, axes=(-2, -1))
        W = w_r + 1j * w_i
        X = X * W
        y = (lambda x, s, axes=(-2, -1): torch.fft.irfft2(x, s=s, dim=axes).to(torch.bfloat16))(X, (S, D), axes=(-2, -1))
        return y

    def _B_ref(x, w_r, w_gate, w_up, w_down):
        B, S, D = x.shape
        C = 1
        r = x @ w_r
        idx = torch.argsort(-r, axis=-1)[:, :C]
        idx_e = (lambda x, n, axis: torch.repeat_interleave(x, n, dim=axis))(idx.reshape(B, C, 1), D, axis=2)
        x_sel = (lambda x, i, axis: torch.take_along_dim(x, i, dim=axis))(x, idx_e, axis=1)
        g = _silu(x_sel @ w_gate)
        u = x_sel @ w_up
        y = g * u @ w_down
        r_sel = _sigmoid((lambda x, i, axis: torch.take_along_dim(x, i, dim=axis))(r, idx, axis=1))
        y = y * r_sel.reshape(B, C, 1)
        b_off = (torch.arange(B) * S).reshape(B, 1)
        flat_idx = (idx + b_off).reshape(B * C)
        zero = (x * 0.0).reshape(B * S, D)
        upd = _scatter_add(zero, flat_idx, y.reshape(B * C, D), axis=0)
        return x + upd.reshape(B, S, D)
    x = A_x
    mod = (_silu(c) @ w_mod).reshape(c.shape[0], 6, 1, -1)
    sa, ca, ga, sb, cb, gb = (mod[:, 0].clone(), mod[:, 1].clone(), mod[:, 2].clone(), mod[:, 3].clone(), mod[:, 4].clone(), mod[:, 5].clone())
    h = _layernorm(x, axis=-1) * (1 + ca) + sa
    x = x + ga * _A_ref(h, A_w_r, A_w_i)
    h = _layernorm(x, axis=-1) * (1 + cb) + sb
    x = x + gb * _B_ref(h, B_w_r, B_w_gate, B_w_up, B_w_down)
    return x
```

```asm
; @launch grid=(256,1,1) block=(640,1,1) lds=154048
.amdgcn_target "amdgcn-amd-amdhsa--gfx950"
.text
.globl adaLN_cond__spectral_gfnet__moe_arch_mod__prompt_kernel
.p2align 8
.type adaLN_cond__spectral_gfnet__moe_arch_mod__prompt_kernel,@function
adaLN_cond__spectral_gfnet__moe_arch_mod__prompt_kernel:
    s_cmp_ge_u32 s2, 256
    s_cbranch_scc1 L_end
    s_load_dwordx16 s[8:23], s[0:1], 0
    s_load_dwordx8 s[24:31], s[0:1], 64
    s_load_dwordx2 s[32:33], s[0:1], 96
    v_lshrrev_b32 v20, 6, v0
    s_and_b32 s4, s2, 7
    s_lshr_b32 s5, s2, 3
    v_readfirstlane_b32 s3, v20
    v_and_b32 v1, 63, v0
    s_lshl_b32 s6, s4, 5
    s_add_u32 s6, s6, s5
    v_lshlrev_b32 v2, 4, v1
    v_lshlrev_b32 v3, 2, v1
    s_cmp_eq_u32 s3, 9
    s_cbranch_scc1 L_h1
    s_cmp_eq_u32 s3, 8
    s_cbranch_scc1 L_h0
    s_cmp_eq_u32 s5, 30
    s_cbranch_scc0 L_nopf
    s_cmp_ge_u32 s3, (L_tables_end-adaLN_cond__spectral_gfnet__moe_arch_mod__prompt_kernel)/8192
    s_cbranch_scc1 L_nopf
    s_getpc_b64 s[34:35]
L_pc0:
    s_sub_u32 s34, s34, L_pc0-adaLN_cond__spectral_gfnet__moe_arch_mod__prompt_kernel
    s_subb_u32 s35, s35, 0
    v_lshlrev_b32 v21, 7, v0
    global_load_dword v157, v21, s[34:35]
L_nopf:
    s_mul_i32 s54, s4, 25
    s_add_u32 s54, s54, s5
    s_cmp_lt_u32 s54, 45
    s_cselect_b32 s42, -5, 35
    s_add_u32 s54, s54, s42
    s_mul_i32 s42, s4, 5
    s_add_u32 s42, s42, s5
    s_add_u32 s42, s42, 40
    s_cmp_lt_u32 s5, 5
    s_cselect_b32 s54, s42, s54
    s_cmp_lt_u32 s5, 30
    s_cselect_b32 s54, s54, 0xf1
    v_lshrrev_b32 v159, 3, v1
    v_mad_u32_u24 v159, v20, 20, v159
    v_and_b32 v21, 3, s54
    v_mul_u32_u24 v21, 160, v21
    v_add_u32 v159, v159, v21
    v_lshrrev_b32 v21, 2, s54
    v_and_b32 v158, 0x70, v2
    v_lshl_add_u32 v158, v21, 7, v158
    v_mul_u32_u24 v21, 7680, v159
    v_add_u32 v158, v158, v21
    v_lshlrev_b32 v159, 1, v159
    v_lshl_add_u32 v156, v20, 8, s6
    v_mul_u32_u24 v156, 1280, v156
    v_add_u32 v156, v156, v3
    v_mov_b32 v138, 0
    v_mov_b32 v139, 0
    v_mov_b32 v140, 0
    v_mov_b32 v141, 0
    v_mov_b32 v144, 0
    s_cmp_lt_u32 s5, 5
    s_waitcnt lgkmcnt(0)
    s_cbranch_scc1 L_a
    global_load_dword v150, v156, s[8:9] offset:0 nt
    global_load_dword v151, v156, s[8:9] offset:256 nt
    global_load_dword v152, v156, s[8:9] offset:512 nt
    global_load_dword v153, v156, s[8:9] offset:768 nt
    global_load_dword v154, v156, s[8:9] offset:1024 nt
    s_branch L_a0
L_a:
    global_load_dwordx4 v[130:133], v158, s[26:27] nt
    v_add_u32 v158, 61440, v158
    global_load_dwordx4 v[134:137], v158, s[26:27] nt
    v_add_u32 v158, 61440, v158
    s_mov_b32 exec_hi, 0
    global_load_dwordx4 v[138:141], v158, s[26:27] nt
    s_mov_b64 exec, -1
    s_and_b32 s42, s54, 3
    s_lshl_b32 s42, s42, 3
    s_add_u32 s42, s42, s3
    s_mul_i32 s42, s42, 40
    s_load_dwordx8 s[56:63], s[24:25], s42
    s_add_u32 s42, s42, 32
    s_load_dwordx2 s[64:65], s[24:25], s42
    s_cmp_lg_u32 s3, 0
    s_cbranch_scc1 L_a0
    v_lshl_add_u32 v36, s54, 8, v3
    v_mov_b32 v37, 0
    global_store_dword v36, v37, s[32:33] sc1
L_a0:
    s_load_dword s55, s[32:33], 73728
    v_lshrrev_b32 v20, 4, v1
    v_bfe_u32 v21, v1, 2, 2
    v_bfe_u32 v22, v1, 1, 1
    v_lshl_add_u32 v21, v22, 2, v21
    v_lshlrev_b32 v20, 9, v20
    v_add_u32 v20, s6, v20
    v_mul_u32_u24 v22, v20, v21
    v_lshl_add_u32 v23, v21, 8, v22
    v_and_b32 v20, 1, v1
    v_lshl_add_u32 v22, v20, 9, v22
    v_lshl_add_u32 v23, v20, 9, v23
    v_and_b32 v22, 0x7ff, v22
    v_and_b32 v23, 0x7ff, v23
    v_cvt_f32_u32 v22, v22
    v_cvt_f32_u32 v23, v23
    v_mul_f32 v22, 0x3a000000, v22
    v_mul_f32 v23, 0x3a000000, v23
    v_cos_f32 v20, v22
    v_sin_f32 v22, v22
    v_cos_f32 v21, v23
    v_sin_f32 v23, v23
    v_cvt_pk_bf16_f32 v6, v20, v22
    v_cvt_pk_bf16_f32 v7, v21, v23
    s_cmp_lt_u32 s5, 5
    s_cbranch_scc0 L_a00
    global_load_dword v150, v156, s[8:9] offset:0 nt
    global_load_dword v151, v156, s[8:9] offset:256 nt
    global_load_dword v152, v156, s[8:9] offset:512 nt
    global_load_dword v153, v156, s[8:9] offset:768 nt
    global_load_dword v154, v156, s[8:9] offset:1024 nt
L_a00:
    v_lshrrev_b32 v20, 4, v1
    v_bfe_u32 v21, v1, 1, 3
    v_lshlrev_b32 v21, 8, v21
    v_add_u32 v21, s6, v21
    v_mul_u32_u24 v22, v20, v21
    v_xor_b32 v20, 4, v20
    v_mul_u32_u24 v23, v20, v21
    v_sub_u32 v22, 0, v22
    v_sub_u32 v23, 0, v23
    v_and_b32 v20, 1, v1
    v_lshl_add_u32 v22, v20, 9, v22
    v_lshl_add_u32 v23, v20, 9, v23
    v_and_b32 v22, 0x7ff, v22
    v_and_b32 v23, 0x7ff, v23
    v_cvt_f32_u32 v22, v22
    v_cvt_f32_u32 v23, v23
    v_mul_f32 v22, 0x3a000000, v22
    v_mul_f32 v23, 0x3a000000, v23
    v_cos_f32 v20, v22
    v_sin_f32 v22, v22
    v_cos_f32 v21, v23
    v_sin_f32 v23, v23
    v_cvt_pk_bf16_f32 v8, v20, v22
    v_cvt_pk_bf16_f32 v9, v21, v23
    v_bfe_u32 v20, v1, 2, 2
    v_and_b32 v21, 48, v2
    v_lshrrev_b32 v22, 4, v1
    v_lshl_add_u32 v23, v22, 5, v20
    v_mul_u32_u24 v5, 11392, v23
    v_add_u32 v5, v5, v21
    v_mul_u32_u24 v23, 80, v23
    s_mul_i32 s7, s3, 320
    s_add_u32 s7, s7, 28736
    v_add3_u32 v164, v23, v21, s7
    v_mul_u32_u24 v4, 1408, v22
    v_and_b32 v23, 0xf0, v2
    v_add_u32 v4, v4, v23
    v_lshlrev_b32 v160, 3, v1
    v_mul_u32_u24 v22, 2944, v22
    v_mul_u32_u24 v20, 120, v20
    v_lshl_add_u32 v20, v21, 1, v20
    s_min_u32 s7, s3, 5
    s_mul_i32 s7, s7, 480
    s_add_u32 s7, s7, 49216
    v_add3_u32 v165, v20, v22, s7
    s_cmp_lt_u32 s5, 5
    s_cbranch_scc0 L_setup
    s_cmp_lg_u32 s3, 0
    s_cbranch_scc1 L_a1
    s_waitcnt lgkmcnt(0)
    s_and_b32 s50, s55, 0x7f7f7f7f
    s_add_u32 s50, s50, 0x01010101
    s_or_b32 s50, s50, 0x80808080
    v_lshlrev_b32 v28, 5, v1
    v_lshlrev_b32 v34, 3, v1
    v_and_b32 v34, 24, v34
    v_bfe_u32 v34, s50, v34, 8
    v_mov_b32 v33, 0xffffff00
    s_sub_u32 s42, s54, 40
    s_cmp_lt_u32 s42, 40
    s_cselect_b32 s43, 1.0, 0
    s_and_b32 s42, s54, 3
    s_cselect_b32 s43, 0, s43
    v_mov_b32 v35, s43
L_a1:
    v_lshlrev_b32 v56, 1, v1
    v_and_b32 v56, 16, v56
    s_waitcnt lgkmcnt(0)
    s_mov_b64 exec, 0xffff
    v_lshrrev_b32 v142, v56, s56
    v_lshrrev_b32 v143, v56, s60
    v_lshrrev_b32 v144, v56, s64
    s_lshl_b64 exec, exec, 16
    v_lshrrev_b32 v142, v56, s57
    v_lshrrev_b32 v143, v56, s61
    v_lshrrev_b32 v144, v56, s65
    s_lshl_b64 exec, exec, 16
    v_lshrrev_b32 v142, v56, s58
    v_lshrrev_b32 v143, v56, s62
    s_lshl_b64 exec, exec, 16
    v_lshrrev_b32 v142, v56, s59
    v_lshrrev_b32 v143, v56, s63
    s_mov_b64 exec, -1
    v_lshlrev_b32 v142, 16, v142
    v_lshlrev_b32 v143, 16, v143
    v_lshlrev_b32 v144, 16, v144
    v_mul_f32 v56, 0xbfb8aa3b, v142
    v_mul_f32 v57, 0xbfb8aa3b, v143
    v_mul_f32 v58, 0xbfb8aa3b, v144
    v_exp_f32 v56, v56
    v_exp_f32 v57, v57
    v_exp_f32 v58, v58
    v_add_f32 v56, 1.0, v56
    v_add_f32 v57, 1.0, v57
    v_add_f32 v58, 1.0, v58
    v_rcp_f32 v56, v56
    v_rcp_f32 v57, v57
    v_rcp_f32 v58, v58
    v_mul_f32 v142, v142, v56
    v_mul_f32 v143, v143, v57
    v_mul_f32 v144, v144, v58
    v_cvt_pk_bf16_f32 v145, v142, 0
    v_cvt_pk_bf16_f32 v147, v143, 0
    v_cvt_pk_bf16_f32 v149, v144, 0
    v_lshlrev_b32 v146, 16, v145
    v_lshlrev_b32 v148, 16, v147
    v_lshlrev_b32 v59, 16, v149
    v_and_b32 v158, 7, v1
    v_lshlrev_b32 v158, 8, v158
    v_and_b32 v159, 48, v1
    v_lshl_add_u32 v158, v159, 2, v158
    s_lshl_b32 s7, s3, 2
    s_add_u32 s7, s7, 26624
    v_add_u32 v158, s7, v158
    v_mov_b32 v48, 0
    v_mov_b32 v49, 0
    v_mov_b32 v50, 0
    v_mov_b32 v51, 0
    v_mov_b32 v52, 0
    v_mov_b32 v53, 0
    v_mov_b32 v54, 0
    v_mov_b32 v55, 0
    s_waitcnt vmcnt(7)
    v_dot2c_f32_bf16 v48, v130, v145
    v_dot2c_f32_bf16 v52, v132, v145
    v_dot2c_f32_bf16 v49, v130, v146
    v_dot2c_f32_bf16 v53, v132, v146
    v_dot2c_f32_bf16 v50, v131, v145
    v_dot2c_f32_bf16 v54, v133, v145
    v_dot2c_f32_bf16 v51, v131, v146
    v_dot2c_f32_bf16 v55, v133, v146
    s_waitcnt vmcnt(6)
    v_dot2c_f32_bf16 v48, v134, v147
    v_dot2c_f32_bf16 v52, v136, v147
    v_dot2c_f32_bf16 v49, v134, v148
    v_dot2c_f32_bf16 v53, v136, v148
    v_dot2c_f32_bf16 v50, v135, v147
    v_dot2c_f32_bf16 v54, v137, v147
    v_dot2c_f32_bf16 v51, v135, v148
    v_dot2c_f32_bf16 v55, v137, v148
    s_waitcnt vmcnt(5)
    v_dot2c_f32_bf16 v48, v138, v149
    v_dot2c_f32_bf16 v52, v140, v149
    v_dot2c_f32_bf16 v49, v138, v59
    v_dot2c_f32_bf16 v53, v140, v59
    v_dot2c_f32_bf16 v50, v139, v149
    v_dot2c_f32_bf16 v54, v141, v149
    v_dot2c_f32_bf16 v51, v139, v59
    v_dot2c_f32_bf16 v55, v141, v59
    v_permlane32_swap_b32 v48, v52
    v_permlane32_swap_b32 v49, v53
    v_permlane32_swap_b32 v50, v54
    v_permlane32_swap_b32 v51, v55
    v_pk_add_f32 v[48:49], v[48:49], v[52:53]
    v_pk_add_f32 v[50:51], v[50:51], v[54:55]
    s_nop 1
    v_permlane16_swap_b32 v48, v50
    v_permlane16_swap_b32 v49, v51
    v_pk_add_f32 v[48:49], v[48:49], v[50:51]
    s_nop 1
    v_add_f32_dpp v48, v48, v48 row_ror:8 row_mask:0xf bank_mask:0xf
    v_add_f32_dpp v49, v49, v49 row_ror:8 row_mask:0xf bank_mask:0xf
    s_mov_b32 exec_lo, 0x00ff00ff
    s_mov_b32 exec_hi, 0x00ff00ff
    ds_write2_b32 v158, v48, v49 offset0:0 offset1:8
    s_mov_b64 exec, -1
    s_waitcnt lgkmcnt(0)
    s_cmp_lg_u32 s3, 0
    s_barrier
    s_cbranch_scc1 L_a2
    ds_read_b128 v[40:43], v28 offset:26624
    ds_read_b128 v[44:47], v28 offset:26640
    v_lshl_add_u32 v36, s54, 8, v3
    s_waitcnt lgkmcnt(0)
    v_pk_add_f32 v[40:41], v[40:41], v[42:43]
    v_pk_add_f32 v[44:45], v[44:45], v[46:47]
    v_add_f32 v40, v35, v40
    v_pk_add_f32 v[40:41], v[40:41], v[44:45]
    v_add_f32 v40, v40, v41
    v_and_or_b32 v40, v40, v33, v34
    global_store_dword v36, v40, s[32:33] sc1
L_a2:
    s_barrier
L_setup:
    s_mov_b32 s52, 0xffff0000
    s_lshl_b32 s48, s3, 8
    s_add_u32 s49, s48, s6
    s_mul_i32 s48, s49, 1280
    s_mov_b32 s44, 0x77777777
    s_mov_b32 s45, 0x77777777
    s_mov_b32 s62, 0x88888888
    s_mov_b32 s63, 0x88888888
    s_mov_b32 s66, 0x37773777
    s_mov_b32 s67, 0x37773777
    s_cmp_eq_u32 s3, 5
    s_cselect_b32 s64, 0x00ff00ff, -1
    s_mov_b32 s65, s64
    s_cmp_lt_u32 s5, 5
    s_cbranch_scc1 L_xw
    s_sub_u32 s7, s5, 5
    s_cmp_lt_u32 s7, 25
    s_cbranch_scc0 L_nb
    global_load_ushort v142, v159, s[24:25] offset:0
    global_load_ushort v143, v159, s[24:25] offset:16
    s_mov_b32 exec_hi, 0
    global_load_ushort v144, v159, s[24:25] offset:32
    s_mov_b64 exec, -1
    global_load_dwordx4 v[130:133], v158, s[26:27] nt
    v_add_u32 v158, 61440, v158
    global_load_dwordx4 v[134:137], v158, s[26:27] nt
    v_add_u32 v158, 61440, v158
    s_mov_b32 exec_hi, 0
    global_load_dwordx4 v[138:141], v158, s[26:27] nt
    s_mov_b64 exec, -1
L_nb:
    s_barrier
    s_waitcnt vmcnt(6)
    s_cbranch_scc1 L_ln1
    s_waitcnt vmcnt(0)
L_xw:
    s_cmp_eq_u32 s3, 0
    s_waitcnt vmcnt(1)
    s_cbranch_scc1 L_ln1
    s_waitcnt vmcnt(0)
L_ln1:
    v_lshlrev_b32 v10, 16, v150
    v_and_b32 v14, s52, v150
    v_lshlrev_b32 v11, 16, v151
    v_and_b32 v15, s52, v151
    v_lshlrev_b32 v12, 16, v152
    v_and_b32 v16, s52, v152
    v_lshlrev_b32 v13, 16, v153
    v_and_b32 v17, s52, v153
    v_lshlrev_b32 v18, 16, v154
    v_and_b32 v19, s52, v154
    v_pk_add_f32 v[24:25], v[10:11], v[12:13]
    v_pk_add_f32 v[24:25], v[24:25], v[14:15]
    v_pk_add_f32 v[24:25], v[24:25], v[16:17]
    v_pk_add_f32 v[24:25], v[24:25], v[18:19]
    v_add_f32 v24, v24, v25
    s_nop 1
    v_add_f32_dpp v24, v24, v24 row_ror:8 row_mask:0xf bank_mask:0xf
    s_nop 1
    v_add_f32_dpp v24, v24, v24 row_ror:4 row_mask:0xf bank_mask:0xf
    s_nop 1
    v_add_f32_dpp v24, v24, v24 row_ror:2 row_mask:0xf bank_mask:0xf
    s_nop 1
    v_add_f32_dpp v24, v24, v24 row_ror:1 row_mask:0xf bank_mask:0xf
    s_nop 1
    v_add_f32_dpp v24, v24, v24 row_bcast:15 row_mask:0xa bank_mask:0xf
    s_nop 1
    v_add_f32_dpp v24, v24, v24 row_bcast:31 row_mask:0xc bank_mask:0xf
    s_nop 0
    v_readlane_b32 s42, v24, 63
    v_mov_b32 v24, 0x3acccccd
    s_nop 0
    v_mul_f32 v26, s42, v24
    v_cvt_pk_bf16_f32 v28, v26, v26
    v_and_b32 v28, s52, v28
    s_nop 0
    v_readfirstlane_b32 s41, v28
    v_pk_add_f32 v[10:11], v[10:11], v[28:29] op_sel:[0,0] op_sel_hi:[1,0] neg_lo:[0,1] neg_hi:[0,1]
    v_pk_add_f32 v[12:13], v[12:13], v[28:29] op_sel:[0,0] op_sel_hi:[1,0] neg_lo:[0,1] neg_hi:[0,1]
    v_pk_add_f32 v[14:15], v[14:15], v[28:29] op_sel:[0,0] op_sel_hi:[1,0] neg_lo:[0,1] neg_hi:[0,1]
    v_pk_add_f32 v[16:17], v[16:17], v[28:29] op_sel:[0,0] op_sel_hi:[1,0] neg_lo:[0,1] neg_hi:[0,1]
    v_pk_add_f32 v[18:19], v[18:19], v[28:29] op_sel:[0,0] op_sel_hi:[1,0] neg_lo:[0,1] neg_hi:[0,1]
    v_pk_mul_f32 v[30:31], v[10:11], v[10:11]
    v_pk_fma_f32 v[30:31], v[12:13], v[12:13], v[30:31]
    v_pk_fma_f32 v[30:31], v[14:15], v[14:15], v[30:31]
    v_pk_fma_f32 v[30:31], v[16:17], v[16:17], v[30:31]
    v_pk_fma_f32 v[30:31], v[18:19], v[18:19], v[30:31]
    v_add_f32 v30, v30, v31
    s_nop 1
    v_add_f32_dpp v30, v30, v30 row_ror:8 row_mask:0xf bank_mask:0xf
    s_nop 1
    v_add_f32_dpp v30, v30, v30 row_ror:4 row_mask:0xf bank_mask:0xf
    s_nop 1
    v_add_f32_dpp v30, v30, v30 row_ror:2 row_mask:0xf bank_mask:0xf
    s_nop 1
    v_add_f32_dpp v30, v30, v30 row_ror:1 row_mask:0xf bank_mask:0xf
    s_nop 1
    v_add_f32_dpp v30, v30, v30 row_bcast:15 row_mask:0xa bank_mask:0xf
    s_nop 1
    v_add_f32_dpp v30, v30, v30 row_bcast:31 row_mask:0xc bank_mask:0xf
    s_nop 0
    v_readlane_b32 s42, v30, 63
    v_sub_f32 v26, v26, v28
    v_mul_f32 v26, v26, v26
    v_fma_f32 v26, s42, v24, -v26
    v_cvt_pk_bf16_f32 v27, v26, v26
    v_and_b32 v27, s52, v27
    v_add_f32 v27, 0x3727c5ac, v27
    v_cvt_pk_bf16_f32 v27, v27, v27
    v_and_b32 v27, s52, v27
    v_sqrt_f32 v27, v27
    s_nop 0
    v_cvt_pk_bf16_f32 v27, v27, v27
    v_and_b32 v27, s52, v27
    v_rcp_f32 v27, v27
    s_nop 0
    v_mul_f32 v120, v27, v10
    v_mul_f32 v121, v27, v14
    v_mul_f32 v122, v27, v11
    v_mul_f32 v123, v27, v15
    v_mul_f32 v124, v27, v12
    v_mul_f32 v125, v27, v16
    v_mul_f32 v126, v27, v13
    v_mul_f32 v127, v27, v17
    v_mul_f32 v128, v27, v18
    v_mul_f32 v129, v27, v19
    v_mov_b32 v23, 0
    v_mov_b32 v27, 0
    s_waitcnt lgkmcnt(0)
    s_and_b32 s55, s55, 0x7f7f7f7f
    s_add_u32 s55, s55, 0x01010101
    s_or_b32 s55, s55, 0x80808080
    s_bfe_u32 s68, s55, 0x80000
    s_bfe_u32 s69, s55, 0x80008
    s_bfe_u32 s70, s55, 0x80010
    s_bfe_u32 s71, s55, 0x80018
    s_mul_i32 s42, s6, 11392
    s_lshl_b32 s43, s3, 8
    s_add_u32 s42, s42, s43
    s_add_u32 s7, s42, 4194304
    s_add_u32 s34, s32, s7
    s_addc_u32 s35, s33, 0
    s_add_u32 s7, s42, 4199936
    s_add_u32 s36, s32, s7
    s_addc_u32 s37, s33, 0
    v_subrev_u32 v28, 64, v0
    v_lshrrev_b32 v29, 4, v28
    v_lshlrev_b32 v29, 10, v29
    v_and_b32 v30, 0xf0, v2
    v_add_u32 v29, v29, v30
    s_mov_b32 s46, 60992
    v_add_u32 v29, 10240, v29
    v_bfe_u32 v31, v28, 5, 1
    v_lshlrev_b32 v31, 3, v31
    v_and_b32 v30, 31, v28
    v_lshl_add_u32 v31, v30, 5, v31
    v_lshrrev_b32 v28, 6, v28
    v_lshlrev_b32 v28, 10, v28
    v_add3_u32 v28, v28, v31, s46
    s_cmp_eq_u32 s3, 3
    s_cselect_b32 s39, 0, -1
    s_mov_b32 s38, -1
    v_add_u32 v163, s46, v2
    s_lshr_b32 s43, s3, 1
    s_mul_i32 s43, s43, 2944
    s_and_b32 s7, s3, 1
    s_lshl_b32 s7, s7, 2
    s_add_u32 s43, s43, s7
    s_add_u32 s43, s43, 49216
    s_barrier
    ds_read_b128 v[108:111], v2 offset:0
    ds_read_b128 v[112:115], v2 offset:1024
    ds_read_b128 v[92:95], v2 offset:2048
    ds_read_b128 v[96:99], v2 offset:3072
    ds_read_b128 v[100:103], v2 offset:4096
    ds_read_b128 v[104:107], v2 offset:5120
    ds_read_b128 v[60:63], v2 offset:6144
    ds_read_b128 v[64:67], v2 offset:7168
    ds_read_b128 v[76:79], v2 offset:8192
    ds_read_b128 v[80:83], v2 offset:9216
    ds_read_b128 v[32:35], v2 offset:10240
    s_waitcnt lgkmcnt(0)
    v_add_u32 v161, s43, v32
    v_add_u32 v162, 160, v161
    v_alignbit_b32 v68, v60, v60, 16
    v_xor_b32 v68, v33, v68
    v_alignbit_b32 v69, v61, v61, 16
    v_xor_b32 v69, v33, v69
    v_alignbit_b32 v70, v62, v62, 16
    v_xor_b32 v70, v33, v70
    v_alignbit_b32 v71, v63, v63, 16
    v_xor_b32 v71, v33, v71
    v_alignbit_b32 v72, v64, v64, 16
    v_xor_b32 v72, v33, v72
    v_alignbit_b32 v73, v65, v65, 16
    v_xor_b32 v73, v33, v73
    v_alignbit_b32 v74, v66, v66, 16
    v_xor_b32 v74, v33, v74
    v_alignbit_b32 v75, v67, v67, 16
    v_xor_b32 v75, v33, v75
    v_alignbit_b32 v84, v76, v76, 16
    v_xor_b32 v84, v33, v84
    v_alignbit_b32 v85, v77, v77, 16
    v_xor_b32 v85, v33, v85
    v_alignbit_b32 v86, v78, v78, 16
    v_xor_b32 v86, v33, v86
    v_alignbit_b32 v87, v79, v79, 16
    v_xor_b32 v87, v33, v87
    v_alignbit_b32 v88, v80, v80, 16
    v_xor_b32 v88, v33, v88
    v_alignbit_b32 v89, v81, v81, 16
    v_xor_b32 v89, v33, v89
    v_alignbit_b32 v90, v82, v82, 16
    v_xor_b32 v90, v33, v90
    v_alignbit_b32 v91, v83, v83, 16
    v_xor_b32 v91, v33, v91
    s_sub_u32 s7, s5, 5
    s_cmp_lt_u32 s7, 25
    s_cbranch_scc0 L_ng_1
    s_waitcnt vmcnt(3)
    v_lshlrev_b32 v142, 16, v142
    v_lshlrev_b32 v143, 16, v143
    v_lshlrev_b32 v144, 16, v144
    v_mul_f32 v56, 0xbfb8aa3b, v142
    v_mul_f32 v57, 0xbfb8aa3b, v143
    v_mul_f32 v58, 0xbfb8aa3b, v144
    v_exp_f32 v56, v56
    v_exp_f32 v57, v57
    v_exp_f32 v58, v58
    v_add_f32 v56, 1.0, v56
    v_add_f32 v57, 1.0, v57
    v_add_f32 v58, 1.0, v58
    v_rcp_f32 v56, v56
    v_rcp_f32 v57, v57
    v_rcp_f32 v58, v58
    v_mul_f32 v142, v142, v56
    v_mul_f32 v143, v143, v57
    v_mul_f32 v144, v144, v58
    v_cvt_pk_bf16_f32 v145, v142, 0
    v_cvt_pk_bf16_f32 v147, v143, 0
    v_cvt_pk_bf16_f32 v149, v144, 0
    v_lshlrev_b32 v146, 16, v145
    v_lshlrev_b32 v148, 16, v147
    v_lshlrev_b32 v59, 16, v149
    v_and_b32 v158, 7, v1
    v_lshlrev_b32 v158, 8, v158
    v_and_b32 v159, 48, v1
    v_lshl_add_u32 v158, v159, 2, v158
    s_lshl_b32 s7, s3, 2
    s_add_u32 s7, s7, 26624
    v_add_u32 v158, s7, v158
    v_mov_b32 v150, 0
    v_mov_b32 v151, 0
    v_mov_b32 v152, 0
    v_mov_b32 v153, 0
    v_mov_b32 v154, 0
    v_mov_b32 v155, 0
    v_mov_b32 v156, 0
    v_mov_b32 v157, 0
    s_waitcnt vmcnt(2)
    v_dot2c_f32_bf16 v150, v130, v145
    v_dot2c_f32_bf16 v154, v132, v145
    v_dot2c_f32_bf16 v151, v130, v146
    v_dot2c_f32_bf16 v155, v132, v146
    v_dot2c_f32_bf16 v152, v131, v145
    v_dot2c_f32_bf16 v156, v133, v145
    v_dot2c_f32_bf16 v153, v131, v146
    v_dot2c_f32_bf16 v157, v133, v146
    s_waitcnt vmcnt(1)
    v_dot2c_f32_bf16 v150, v134, v147
    v_dot2c_f32_bf16 v154, v136, v147
    v_dot2c_f32_bf16 v151, v134, v148
    v_dot2c_f32_bf16 v155, v136, v148
    v_dot2c_f32_bf16 v152, v135, v147
    v_dot2c_f32_bf16 v156, v137, v147
    v_dot2c_f32_bf16 v153, v135, v148
    v_dot2c_f32_bf16 v157, v137, v148
    s_waitcnt vmcnt(0)
    v_dot2c_f32_bf16 v150, v138, v149
    v_dot2c_f32_bf16 v154, v140, v149
    v_dot2c_f32_bf16 v151, v138, v59
    v_dot2c_f32_bf16 v155, v140, v59
    v_dot2c_f32_bf16 v152, v139, v149
    v_dot2c_f32_bf16 v156, v141, v149
    v_dot2c_f32_bf16 v153, v139, v59
    v_dot2c_f32_bf16 v157, v141, v59
    v_permlane32_swap_b32 v150, v154
    v_permlane32_swap_b32 v151, v155
    v_permlane32_swap_b32 v152, v156
    v_permlane32_swap_b32 v153, v157
    v_pk_add_f32 v[150:151], v[150:151], v[154:155]
    v_pk_add_f32 v[152:153], v[152:153], v[156:157]
    s_nop 1
    v_permlane16_swap_b32 v150, v152
    v_permlane16_swap_b32 v151, v153
    v_pk_add_f32 v[150:151], v[150:151], v[152:153]
    s_nop 1
    v_add_f32_dpp v150, v150, v150 row_ror:8 row_mask:0xf bank_mask:0xf
    v_add_f32_dpp v151, v151, v151 row_ror:8 row_mask:0xf bank_mask:0xf
    s_mov_b32 exec_lo, 0x00ff00ff
    s_mov_b32 exec_hi, 0x00ff00ff
    ds_write2_b32 v158, v150, v151 offset0:0 offset1:8
    s_mov_b64 exec, -1
    s_waitcnt lgkmcnt(0)
L_ng_1:
    s_sub_u32 s7, s3, 1
    s_cmp_lt_u32 s7, 3
    s_cbranch_scc1 L_mpoll
    s_barrier
    s_branch L_b2
L_mpoll:
    s_mov_b64 exec, s[38:39]
    global_load_dwordx4 v[36:39], v29, s[32:33] offset:0 sc1
    global_load_dwordx4 v[40:43], v29, s[32:33] offset:256 sc1
    global_load_dwordx4 v[44:47], v29, s[32:33] offset:512 sc1
    global_load_dwordx4 v[48:51], v29, s[32:33] offset:768 sc1
    s_mov_b32 s40, 1000000
    s_barrier
    s_waitcnt vmcnt(0)
L_pollc_4:
    v_xor_b32 v36, s68, v36
    v_xor_b32 v37, s69, v37
    v_xor_b32 v38, s70, v38
    v_xor_b32 v39, s71, v39
    v_xor_b32 v40, s68, v40
    v_xor_b32 v41, s69, v41
    v_xor_b32 v42, s70, v42
    v_xor_b32 v43, s71, v43
    v_xor_b32 v44, s68, v44
    v_xor_b32 v45, s69, v45
    v_xor_b32 v46, s70, v46
    v_xor_b32 v47, s71, v47
    v_xor_b32 v48, s68, v48
    v_xor_b32 v49, s69, v49
    v_xor_b32 v50, s70, v50
    v_xor_b32 v51, s71, v51
    v_or3_b32 v52, v36, v37, v38
    v_or3_b32 v53, v39, v40, v41
    v_or3_b32 v54, v42, v43, v44
    v_or3_b32 v52, v52, v45, v46
    v_or3_b32 v53, v53, v47, v48
    v_or3_b32 v54, v54, v49, v50
    v_or3_b32 v52, v52, v51, v53
    v_or_b32 v52, v52, v54
    v_and_b32 v52, 0xff, v52
    v_cmpx_ne_u32 vcc, 0, v52
    s_cbranch_execnz L_poll_2
L_polld_3:
    s_mov_b64 exec, -1
    v_pk_add_f32 v[36:37], v[36:37], v[40:41]
    v_pk_add_f32 v[38:39], v[38:39], v[42:43]
    v_pk_add_f32 v[44:45], v[44:45], v[48:49]
    v_pk_add_f32 v[46:47], v[46:47], v[50:51]
    v_pk_add_f32 v[36:37], v[36:37], v[44:45]
    v_pk_add_f32 v[38:39], v[38:39], v[46:47]
    s_mov_b64 exec, s[38:39]
    ds_write2_b64 v28, v[36:37], v[38:39] offset0:0 offset1:2
    s_mov_b64 exec, -1
L_b2:
    s_waitcnt lgkmcnt(0)
    s_barrier
    ds_read_b128 v[130:133], v163
    ds_read_b128 v[134:137], v163 offset:1024
    ds_read_b64 v[138:139], v163 offset:2048
    s_waitcnt lgkmcnt(2)
    v_pk_mul_f32 v[130:131], v[130:131], v[120:121]
    v_pk_mul_f32 v[132:133], v[132:133], v[122:123]
    v_cvt_pk_bf16_f32 v20, v130, v132
    v_cvt_pk_bf16_f32 v24, v131, v133
    s_waitcnt lgkmcnt(1)
    v_pk_mul_f32 v[134:135], v[134:135], v[124:125]
    v_pk_mul_f32 v[136:137], v[136:137], v[126:127]
    v_cvt_pk_bf16_f32 v21, v134, v136
    v_cvt_pk_bf16_f32 v25, v135, v137
    s_waitcnt lgkmcnt(0)
    v_pk_mul_f32 v[138:139], v[138:139], v[128:129]
    v_cvt_pk_bf16_f32 v22, v138, 0
    v_cvt_pk_bf16_f32 v26, v139, 0
    s_nop 0
    v_mfma_f32_16x16x32_bf16 v[36:39], v[20:23], v[108:111], 0
    v_mfma_f32_16x16x32_bf16 v[40:43], v[20:23], v[112:115], 0
    v_mfma_f32_16x16x32_bf16 v[44:47], v[24:27], v[108:111], 0
    v_mfma_f32_16x16x32_bf16 v[48:51], v[24:27], v[112:115], 0
    s_nop 4
    v_pk_mul_f32 v[28:29], v[36:37], v[92:93]
    v_pk_mul_f32 v[30:31], v[38:39], v[94:95]
    v_pk_mul_f32 v[32:33], v[40:41], v[92:93]
    v_pk_mul_f32 v[34:35], v[42:43], v[94:95]
    v_pk_fma_f32 v[28:29], v[40:41], v[96:97], v[28:29]
    v_pk_fma_f32 v[30:31], v[42:43], v[98:99], v[30:31]
    v_pk_fma_f32 v[32:33], v[36:37], v[96:97], v[32:33] neg_lo:[1,0,0] neg_hi:[1,0,0]
    v_pk_fma_f32 v[34:35], v[38:39], v[98:99], v[34:35] neg_lo:[1,0,0] neg_hi:[1,0,0]
    v_cvt_pk_bf16_f32 v20, v28, v32
    v_cvt_pk_bf16_f32 v21, v29, v33
    v_cvt_pk_bf16_f32 v22, v30, v34
    v_cvt_pk_bf16_f32 v23, v31, v35
    v_pk_mul_f32 v[52:53], v[44:45], v[100:101]
    v_pk_mul_f32 v[54:55], v[46:47], v[102:103]
    v_pk_mul_f32 v[56:57], v[48:49], v[100:101]
    v_pk_mul_f32 v[58:59], v[50:51], v[102:103]
    v_pk_fma_f32 v[52:53], v[48:49], v[104:105], v[52:53]
    v_pk_fma_f32 v[54:55], v[50:51], v[106:107], v[54:55]
    v_pk_fma_f32 v[56:57], v[44:45], v[104:105], v[56:57] neg_lo:[1,0,0] neg_hi:[1,0,0]
    v_pk_fma_f32 v[58:59], v[46:47], v[106:107], v[58:59] neg_lo:[1,0,0] neg_hi:[1,0,0]
    v_cvt_pk_bf16_f32 v24, v52, v56
    v_cvt_pk_bf16_f32 v25, v53, v57
    v_cvt_pk_bf16_f32 v26, v54, v58
    v_cvt_pk_bf16_f32 v27, v55, v59
    v_mfma_f32_16x16x32_bf16 v[36:39], v[60:63], v[20:23], 0
    v_mfma_f32_16x16x32_bf16 v[40:43], v[68:71], v[20:23], 0
    v_mfma_f32_16x16x32_bf16 v[36:39], v[64:67], v[24:27], v[36:39]
    v_mfma_f32_16x16x32_bf16 v[40:43], v[72:75], v[24:27], v[40:43]
    v_mfma_f32_16x16x32_bf16 v[44:47], v[76:79], v[20:23], 0
    v_mfma_f32_16x16x32_bf16 v[48:51], v[84:87], v[20:23], 0
    v_mfma_f32_16x16x32_bf16 v[44:47], v[80:83], v[24:27], v[44:47]
    v_mfma_f32_16x16x32_bf16 v[48:51], v[88:91], v[24:27], v[48:51]
    s_mov_b64 exec, s[66:67]
    s_nop 2
    v_cvt_pk_bf16_f32 v28, v36, v40
    v_cvt_pk_bf16_f32 v29, v37, v41
    v_cvt_pk_bf16_f32 v30, v38, v42
    v_cvt_pk_bf16_f32 v31, v39, v43
    ds_write2_b32 v161, v28, v29 offset0:0 offset1:80
    ds_write2_b32 v161, v30, v31 offset0:160 offset1:240
    v_cvt_pk_bf16_f32 v32, v44, v48
    v_cvt_pk_bf16_f32 v33, v45, v49
    v_cvt_pk_bf16_f32 v34, v46, v50
    v_cvt_pk_bf16_f32 v35, v47, v51
    ds_write2_b32 v162, v32, v33 offset0:0 offset1:80
    ds_write2_b32 v162, v34, v35 offset0:160 offset1:240
    s_mov_b64 exec, -1
    v_mov_b32 v55, s55
    v_mov_b32 v59, s55
    s_cmp_ge_u32 s3, 6
    s_waitcnt lgkmcnt(0)
    s_barrier
    s_cbranch_scc1 L_t1done
    ds_read_b64 v[26:27], v165 offset:24
    ds_read_b64 v[20:21], v165 offset:0
    ds_read_b64 v[22:23], v165 offset:8
    ds_read_b64 v[24:25], v165 offset:16
    s_waitcnt lgkmcnt(3)
    v_mfma_f32_16x16x16_bf16 v[48:51], v[6:7], v[26:27], 0
    s_waitcnt lgkmcnt(2)
    v_mfma_f32_16x16x16_bf16 v[36:39], v[6:7], v[20:21], 0
    s_waitcnt lgkmcnt(1)
    v_mfma_f32_16x16x16_bf16 v[40:43], v[6:7], v[22:23], 0
    s_waitcnt lgkmcnt(0)
    v_mfma_f32_16x16x16_bf16 v[44:47], v[6:7], v[24:25], 0
    s_mov_b64 exec, s[44:45]
    s_nop 0
    v_cvt_pk_bf16_f32 v55, v48, v49
    v_cvt_pk_bf16_f32 v59, v50, v51
    s_mov_b64 exec, s[64:65]
    v_cvt_pk_bf16_f32 v52, v36, v37
    v_cvt_pk_bf16_f32 v53, v40, v41
    s_nop 0
    v_cvt_pk_bf16_f32 v54, v44, v45
    global_store_dwordx4 v4, v[52:55], s[34:35] sc1
    v_cvt_pk_bf16_f32 v56, v38, v39
    v_cvt_pk_bf16_f32 v57, v42, v43
    v_cvt_pk_bf16_f32 v58, v46, v47
    global_store_dwordx4 v4, v[56:59], s[36:37] sc1
    s_mov_b64 exec, -1
L_t1done:
    s_cmp_ge_u32 s5, 22
    s_cbranch_scc1 L_idle
    v_mov_b32 v120, 0
    v_mov_b32 v121, 0
    v_mov_b32 v122, 0
    v_mov_b32 v123, 0
    v_mov_b32 v124, 0
    v_mov_b32 v125, 0
    v_mov_b32 v126, 0
    v_mov_b32 v127, 0
    v_mov_b32 v128, 0
    v_mov_b32 v129, 0
    v_mov_b32 v130, 0
    v_mov_b32 v131, 0
    v_mov_b32 v132, 0
    v_mov_b32 v133, 0
    v_mov_b32 v134, 0
    v_mov_b32 v135, 0
    v_and_b32 v36, 15, v1
    v_and_b32 v37, 48, v1
    v_lshl_add_u32 v36, v37, 2, v36
    v_mul_u32_u24 v163, 80, v36
    s_lshl_b32 s43, s3, 3
    s_add_u32 s43, s43, 28736
    v_add_u32 v163, s43, v163
    v_lshlrev_b32 v36, 5, v36
    v_add_u32 v36, 73280, v36
    v_and_b32 v39, 4, v1
    v_lshlrev_b32 v39, 2, v39
    v_lshlrev_b32 v4, 7, v37
    v_and_b32 v37, 0xf0, v2
    v_add_u32 v4, v4, v37
    s_mul_i32 s42, s4, 22
    s_add_u32 s42, s42, s5
    s_lshl_b32 s43, s42, 6
    s_mul_i32 s7, s3, 45568
    s_add_u32 s43, s43, s7
    s_mul_i32 s42, s42, 16640
    s_lshl_b32 s7, s3, 8
    s_add_u32 s42, s42, s7
    s_mul_i32 s46, s5, 120
    s_lshl_b32 s7, s3, 4
    s_add_u32 s46, s46, s7
    s_add_u32 s46, s46, 151104
    v_mov_b32 v140, s46
    s_add_u32 s7, s43, 4194304
    s_add_u32 s34, s32, s7
    s_addc_u32 s35, s33, 0
    s_add_u32 s7, s43, 5652480
    s_add_u32 s36, s32, s7
    s_addc_u32 s37, s33, 0
    s_add_u32 s7, s42, 8388608
    s_add_u32 s58, s32, s7
    s_addc_u32 s59, s33, 0
    s_add_u32 s7, s42, 8396800
    s_add_u32 s60, s32, s7
    s_addc_u32 s61, s33, 0
    s_barrier
    ds_read_b128 v[92:95], v2 offset:22528
    ds_read_b128 v[100:103], v2 offset:24576
    ds_read_b128 v[96:99], v2 offset:23552
    ds_read_b128 v[104:107], v2 offset:25600
    s_mul_i32 s42, s5, 15
    s_min_u32 s43, s42, 306
    s_add_u32 s46, s43, s4
    s_and_b32 s46, s46, 1
    s_sub_u32 s43, s43, s46
    s_lshl_b32 s7, s3, 1
    s_add_u32 s42, s42, s7
    s_add_u32 s46, s42, 0
    s_sub_u32 s7, s46, s43
    s_min_u32 s7, s7, 15
    s_lshl_b32 s7, s7, 1
    v_xor_b32 v37, s7, v39
    v_add_u32 v37, v37, v36
    ds_read_u16_d16_hi v120, v37 offset:0
    ds_read_u16_d16_hi v121, v37 offset:512
    ds_read_u16_d16_hi v122, v37 offset:1024
    ds_read_u16_d16_hi v123, v37 offset:1536
    ds_read_u16_d16_hi v124, v37 offset:8192
    ds_read_u16_d16_hi v125, v37 offset:8704
    ds_read_u16_d16_hi v126, v37 offset:9216
    ds_read_u16_d16_hi v127, v37 offset:9728
    s_mul_i32 s7, s46, 0x199a
    s_lshr_b32 s7, s7, 16
    s_mul_i32 s7, s7, 10
    s_mov_b32 s47, 0x343889d4
    s_cmp_eq_u32 s7, s46
    s_cselect_b32 s47, 0x33b889d4, s47
    s_waitcnt lgkmcnt(0)
    v_mul_f32 v120, s47, v120
    v_mul_f32 v121, s47, v121
    v_mul_f32 v122, s47, v122
    v_mul_f32 v123, s47, v123
    v_mul_f32 v124, s47, v124
    v_mul_f32 v125, s47, v125
    v_mul_f32 v126, s47, v126
    v_mul_f32 v127, s47, v127
    s_add_u32 s46, s42, 1
    s_sub_u32 s7, s46, s43
    s_min_u32 s7, s7, 15
    s_lshl_b32 s7, s7, 1
    v_xor_b32 v37, s7, v39
    v_add_u32 v37, v37, v36
    ds_read_u16_d16_hi v128, v37 offset:0
    ds_read_u16_d16_hi v129, v37 offset:512
    ds_read_u16_d16_hi v130, v37 offset:1024
    ds_read_u16_d16_hi v131, v37 offset:1536
    ds_read_u16_d16_hi v132, v37 offset:8192
    ds_read_u16_d16_hi v133, v37 offset:8704
    ds_read_u16_d16_hi v134, v37 offset:9216
    ds_read_u16_d16_hi v135, v37 offset:9728
    s_mul_i32 s7, s46, 0x199a
    s_lshr_b32 s7, s7, 16
    s_mul_i32 s7, s7, 10
    s_mov_b32 s47, 0x343889d4
    s_cmp_eq_u32 s7, s46
    s_cselect_b32 s47, 0x33b889d4, s47
    s_waitcnt lgkmcnt(0)
    v_mul_f32 v128, s47, v128
    v_mul_f32 v129, s47, v129
    v_mul_f32 v130, s47, v130
    v_mul_f32 v131, s47, v131
    v_mul_f32 v132, s47, v132
    v_mul_f32 v133, s47, v133
    v_mul_f32 v134, s47, v134
    v_mul_f32 v135, s47, v135
    global_load_dwordx4 v[20:23], v5, s[34:35] sc1
    global_load_dwordx4 v[24:27], v5, s[36:37] sc1
    s_mov_b32 s40, 1000000
    ds_read_b128 v[108:111], v2 offset:15360
    ds_read_b128 v[112:115], v2 offset:16384
    ds_read_b128 v[116:119], v2 offset:17408
    ds_read_b128 v[60:63], v2 offset:18432
    ds_read_b128 v[64:67], v2 offset:19456
    ds_read_b128 v[76:79], v2 offset:20480
    ds_read_b128 v[80:83], v2 offset:21504
    ds_read_b128 v[40:43], v2 offset:10240
    s_waitcnt lgkmcnt(0)
    v_alignbit_b32 v68, v60, v60, 16
    v_xor_b32 v68, v43, v68
    v_xor_b32 v60, v42, v60
    v_alignbit_b32 v69, v61, v61, 16
    v_xor_b32 v69, v43, v69
    v_xor_b32 v61, v42, v61
    v_alignbit_b32 v70, v62, v62, 16
    v_xor_b32 v70, v43, v70
    v_xor_b32 v62, v42, v62
    v_alignbit_b32 v71, v63, v63, 16
    v_xor_b32 v71, v43, v71
    v_xor_b32 v63, v42, v63
    v_alignbit_b32 v72, v64, v64, 16
    v_xor_b32 v72, v43, v72
    v_xor_b32 v64, v42, v64
    v_alignbit_b32 v73, v65, v65, 16
    v_xor_b32 v73, v43, v73
    v_xor_b32 v65, v42, v65
    v_alignbit_b32 v74, v66, v66, 16
    v_xor_b32 v74, v43, v74
    v_xor_b32 v66, v42, v66
    v_alignbit_b32 v75, v67, v67, 16
    v_xor_b32 v75, v43, v75
    v_xor_b32 v67, v42, v67
    v_alignbit_b32 v84, v76, v76, 16
    v_xor_b32 v84, v43, v84
    v_xor_b32 v76, v42, v76
    v_alignbit_b32 v85, v77, v77, 16
    v_xor_b32 v85, v43, v85
    v_xor_b32 v77, v42, v77
    v_alignbit_b32 v86, v78, v78, 16
    v_xor_b32 v86, v43, v86
    v_xor_b32 v78, v42, v78
    v_alignbit_b32 v87, v79, v79, 16
    v_xor_b32 v87, v43, v87
    v_xor_b32 v79, v42, v79
    v_alignbit_b32 v88, v80, v80, 16
    v_xor_b32 v88, v43, v88
    v_xor_b32 v80, v42, v80
    v_alignbit_b32 v89, v81, v81, 16
    v_xor_b32 v89, v43, v89
    v_xor_b32 v81, v42, v81
    v_alignbit_b32 v90, v82, v82, 16
    v_xor_b32 v90, v43, v90
    v_xor_b32 v82, v42, v82
    v_alignbit_b32 v91, v83, v83, 16
    v_xor_b32 v91, v43, v91
    v_xor_b32 v83, v42, v83
    s_waitcnt vmcnt(0)
L_pollc_7:
    v_cmp_ne_u32 vcc, s55, v23
    v_cmp_ne_u32 s[38:39], s55, v27
    s_nop 0
    s_or_b64 vcc, vcc, s[38:39]
    s_and_b64 vcc, vcc, s[62:63]
    s_cbranch_scc1 L_poll_5
L_polld_6:
    ds_write_b128 v164, v[20:23]
    ds_write_b128 v164, v[24:27] offset:10240
    s_cmp_eq_u32 s3, 7
    s_waitcnt lgkmcnt(0)
    s_barrier
    s_cbranch_scc1 L_p2_one
    ds_read_b64 v[28:29], v163 offset:0
    ds_read_b64 v[30:31], v163 offset:1280
    ds_read_b64 v[32:33], v163 offset:2560
    ds_read_b64 v[34:35], v163 offset:3840
    s_waitcnt lgkmcnt(2)
    v_pk_mov_b32 v[20:21], v[28:29], v[30:31] op_sel:[0,0]
    v_pk_mov_b32 v[24:25], v[28:29], v[30:31] op_sel:[1,1]
    s_waitcnt lgkmcnt(0)
    v_pk_mov_b32 v[22:23], v[32:33], v[34:35] op_sel:[0,0]
    v_pk_mov_b32 v[26:27], v[32:33], v[34:35] op_sel:[1,1]
    s_nop 0
    v_mfma_f32_16x16x32_bf16 v[36:39], v[20:23], v[92:95], 0
    v_mfma_f32_16x16x32_bf16 v[40:43], v[20:23], v[96:99], 0
    v_mfma_f32_16x16x32_bf16 v[44:47], v[24:27], v[92:95], 0
    v_mfma_f32_16x16x32_bf16 v[48:51], v[24:27], v[96:99], 0
    ds_read2_b64 v[136:139], v140 offset0:0 offset1:1
    s_nop 3
    v_mul_f32 v28, v36, v100
    v_mul_f32 v29, v37, v101
    v_mul_f32 v30, v38, v102
    v_mul_f32 v31, v39, v103
    v_pk_mul_f32 v[32:33], v[40:41], v[100:101]
    v_pk_mul_f32 v[34:35], v[42:43], v[102:103]
    v_pk_fma_f32 v[28:29], v[40:41], v[104:105], v[28:29]
    v_pk_fma_f32 v[30:31], v[42:43], v[106:107], v[30:31]
    v_pk_fma_f32 v[32:33], v[36:37], v[104:105], v[32:33] neg_lo:[1,0,0] neg_hi:[1,0,0]
    v_pk_fma_f32 v[34:35], v[38:39], v[106:107], v[34:35] neg_lo:[1,0,0] neg_hi:[1,0,0]
    v_pk_mul_f32 v[52:53], v[44:45], v[100:101]
    v_pk_mul_f32 v[54:55], v[46:47], v[102:103]
    v_pk_mul_f32 v[56:57], v[48:49], v[100:101]
    v_pk_mul_f32 v[58:59], v[50:51], v[102:103]
    v_pk_fma_f32 v[52:53], v[48:49], v[104:105], v[52:53]
    v_pk_fma_f32 v[54:55], v[50:51], v[106:107], v[54:55]
    v_pk_fma_f32 v[56:57], v[44:45], v[104:105], v[56:57] neg_lo:[1,0,0] neg_hi:[1,0,0]
    v_pk_fma_f32 v[58:59], v[46:47], v[106:107], v[58:59] neg_lo:[1,0,0] neg_hi:[1,0,0]
    v_cvt_pk_bf16_f32 v20, v28, v32
    v_cvt_pk_bf16_f32 v21, v29, v33
    v_cvt_pk_bf16_f32 v22, v30, v34
    v_cvt_pk_bf16_f32 v23, v31, v35
    v_cvt_pk_bf16_f32 v24, v52, v56
    v_cvt_pk_bf16_f32 v25, v53, v57
    v_mfma_f32_16x16x32_bf16 v[36:39], v[92:95], v[20:23], 0
    v_cvt_pk_bf16_f32 v26, v54, v58
    v_cvt_pk_bf16_f32 v27, v55, v59
    v_mfma_f32_16x16x32_bf16 v[40:43], v[96:99], v[20:23], 0
    s_nop 0
    v_mfma_f32_16x16x32_bf16 v[44:47], v[92:95], v[24:27], 0
    v_mfma_f32_16x16x32_bf16 v[48:51], v[96:99], v[24:27], 0
    s_cmp_eq_u32 s4, 0
    s_cbranch_scc1 L_sa_8
L_sa_9:
    v_mul_f32 v28, v36, v120
    v_mul_f32 v29, v37, v121
    v_mul_f32 v30, v38, v122
    v_mul_f32 v31, v39, v123
    v_pk_mul_f32 v[32:33], v[40:41], v[120:121]
    v_pk_mul_f32 v[34:35], v[42:43], v[122:123]
    v_pk_fma_f32 v[28:29], v[40:41], v[124:125], v[28:29] neg_lo:[1,0,0] neg_hi:[1,0,0]
    v_pk_fma_f32 v[30:31], v[42:43], v[126:127], v[30:31] neg_lo:[1,0,0] neg_hi:[1,0,0]
    v_pk_fma_f32 v[32:33], v[36:37], v[124:125], v[32:33]
    v_pk_fma_f32 v[34:35], v[38:39], v[126:127], v[34:35]
    v_pk_mul_f32 v[52:53], v[44:45], v[128:129]
    v_pk_mul_f32 v[54:55], v[46:47], v[130:131]
    v_pk_mul_f32 v[56:57], v[48:49], v[128:129]
    v_pk_mul_f32 v[58:59], v[50:51], v[130:131]
    v_pk_fma_f32 v[52:53], v[48:49], v[132:133], v[52:53] neg_lo:[1,0,0] neg_hi:[1,0,0]
    v_pk_fma_f32 v[54:55], v[50:51], v[134:135], v[54:55] neg_lo:[1,0,0] neg_hi:[1,0,0]
    v_pk_fma_f32 v[56:57], v[44:45], v[132:133], v[56:57]
    v_pk_fma_f32 v[58:59], v[46:47], v[134:135], v[58:59]
    v_cvt_pk_bf16_f32 v20, v32, v28
    v_cvt_pk_bf16_f32 v21, v33, v29
    v_cvt_pk_bf16_f32 v22, v34, v30
    v_cvt_pk_bf16_f32 v23, v35, v31
    v_cvt_pk_bf16_f32 v24, v56, v52
    v_cvt_pk_bf16_f32 v25, v57, v53
    v_mfma_f32_16x16x32_bf16 v[36:39], v[20:23], v[96:99], 0
    v_cvt_pk_bf16_f32 v26, v58, v54
    v_cvt_pk_bf16_f32 v27, v59, v55
    v_mfma_f32_16x16x32_bf16 v[40:43], v[20:23], v[92:95], 0
    s_nop 0
    v_mfma_f32_16x16x32_bf16 v[44:47], v[24:27], v[96:99], 0
    v_mfma_f32_16x16x32_bf16 v[48:51], v[24:27], v[92:95], 0
    s_nop 1
    v_mul_f32 v28, v36, v100
    v_mul_f32 v29, v37, v101
    v_mul_f32 v30, v38, v102
    v_mul_f32 v31, v39, v103
    v_pk_mul_f32 v[32:33], v[40:41], v[100:101]
    v_pk_mul_f32 v[34:35], v[42:43], v[102:103]
    v_pk_fma_f32 v[28:29], v[40:41], v[104:105], v[28:29] neg_lo:[1,0,0] neg_hi:[1,0,0]
    v_pk_fma_f32 v[30:31], v[42:43], v[106:107], v[30:31] neg_lo:[1,0,0] neg_hi:[1,0,0]
    v_pk_fma_f32 v[32:33], v[36:37], v[104:105], v[32:33]
    v_pk_fma_f32 v[34:35], v[38:39], v[106:107], v[34:35]
    v_pk_mul_f32 v[52:53], v[44:45], v[100:101]
    v_pk_mul_f32 v[54:55], v[46:47], v[102:103]
    v_pk_mul_f32 v[56:57], v[48:49], v[100:101]
    v_pk_mul_f32 v[58:59], v[50:51], v[102:103]
    v_pk_fma_f32 v[52:53], v[48:49], v[104:105], v[52:53] neg_lo:[1,0,0] neg_hi:[1,0,0]
    v_pk_fma_f32 v[54:55], v[50:51], v[106:107], v[54:55] neg_lo:[1,0,0] neg_hi:[1,0,0]
    v_pk_fma_f32 v[56:57], v[44:45], v[104:105], v[56:57]
    v_pk_fma_f32 v[58:59], v[46:47], v[106:107], v[58:59]
    v_cvt_pk_bf16_f32 v20, v32, v28
    v_cvt_pk_bf16_f32 v21, v33, v29
    v_cvt_pk_bf16_f32 v22, v34, v30
    v_cvt_pk_bf16_f32 v23, v35, v31
    v_cvt_pk_bf16_f32 v24, v56, v52
    v_cvt_pk_bf16_f32 v25, v57, v53
    v_mfma_f32_16x16x32_bf16 v[36:39], v[96:99], v[20:23], 0
    v_cvt_pk_bf16_f32 v26, v58, v54
    v_cvt_pk_bf16_f32 v27, v59, v55
    v_mfma_f32_16x16x32_bf16 v[40:43], v[92:95], v[20:23], 0
    s_nop 0
    v_mfma_f32_16x16x32_bf16 v[44:47], v[96:99], v[24:27], 0
    v_mfma_f32_16x16x32_bf16 v[48:51], v[92:95], v[24:27], 0
    s_nop 4
    v_cvt_pk_bf16_f32 v28, v36, v40
    v_cvt_pk_bf16_f32 v30, v37, v41
    v_cvt_pk_bf16_f32 v32, v38, v42
    v_cvt_pk_bf16_f32 v34, v39, v43
    v_cvt_pk_bf16_f32 v29, v44, v48
    v_cvt_pk_bf16_f32 v31, v45, v49
    v_cvt_pk_bf16_f32 v33, v46, v50
    v_cvt_pk_bf16_f32 v35, v47, v51
    ds_write_b64 v163, v[28:29] offset:0
    ds_write_b64 v163, v[30:31] offset:1280
    ds_write_b64 v163, v[32:33] offset:2560
    ds_write_b64 v163, v[34:35] offset:3840
    s_waitcnt lgkmcnt(0)
L_b5:
    s_barrier
    ds_read_b128 v[28:31], v164
    ds_read_b128 v[32:35], v164 offset:10240
    s_waitcnt lgkmcnt(1)
    global_store_dwordx4 v4, v[28:31], s[58:59] sc1
    s_waitcnt lgkmcnt(0)
    global_store_dwordx4 v4, v[32:35], s[60:61] sc1
L_p3prep:
    ds_read_b128 v[92:95], v2 offset:11264
    ds_read_b128 v[96:99], v2 offset:12288
    ds_read_b128 v[100:103], v2 offset:13312
    ds_read_b128 v[104:107], v2 offset:14336
    v_add_u32 v166, 66112, v3
    v_bfe_u32 v36, v1, 2, 2
    v_lshrrev_b32 v37, 4, v1
    v_mad_u32_u24 v36, v37, 22, v36
    v_and_b32 v38, 48, v2
    v_mul_u32_u24 v36, 16640, v36
    v_add_u32 v5, v36, v38
    v_mul_u32_u24 v37, 2944, v37
    v_add_u32 v37, 52104, v37
    v_cndmask_b32 v7, v165, v37, s[62:63]
    s_and_b64 s[62:63], s[62:63], s[64:65]
    s_lshl_b32 s43, s6, 6
    s_min_u32 s7, s3, 5
    s_mul_i32 s7, s7, 66560
    s_add_u32 s43, s43, s7
    s_add_u32 s7, s43, 8388608
    s_add_u32 s34, s32, s7
    s_addc_u32 s35, s33, 0
    s_add_u32 s7, s43, 9852928
    s_add_u32 s36, s32, s7
    s_addc_u32 s37, s33, 0
    s_add_u32 s72, s28, s48
    s_addc_u32 s73, s29, 0
    s_mul_i32 s42, s6, 4224
    s_add_u32 s7, s42, 524288
    s_add_u32 s56, s32, s7
    s_addc_u32 s57, s33, 0
    v_mov_b32 v167, 0xbacccccd
    v_mov_b32 v6, 0xb727c5ac
    v_mov_b32 v163, 28672
    v_mov_b32 v164, 1
    s_waitcnt lgkmcnt(0)
    s_barrier
    ds_read2st64_b32 v[28:29], v166 offset0:0 offset1:1
    ds_read2st64_b32 v[30:31], v166 offset0:2 offset1:3
    ds_read2st64_b32 v[32:33], v166 offset0:4 offset1:5
    ds_read2st64_b32 v[34:35], v166 offset0:6 offset1:7
    ds_read2st64_b32 v[36:37], v166 offset0:8 offset1:9
    ds_read2st64_b32 v[38:39], v166 offset0:10 offset1:11
    ds_read2st64_b32 v[40:41], v166 offset0:12 offset1:13
    ds_read2st64_b32 v[42:43], v166 offset0:14 offset1:15
    ds_read2st64_b32 v[44:45], v166 offset0:16 offset1:17
    ds_read2st64_b32 v[46:47], v166 offset0:18 offset1:19
    ds_read2st64_b32 v[48:49], v166 offset0:20 offset1:21
    ds_read2st64_b32 v[50:51], v166 offset0:22 offset1:23
    ds_read_b32 v52, v166 offset:6144
    s_waitcnt lgkmcnt(0)
    v_lshlrev_b32 v120, 16, v28
    v_and_b32 v124, s52, v28
    v_lshlrev_b32 v121, 16, v29
    v_and_b32 v125, s52, v29
    v_lshlrev_b32 v122, 16, v30
    v_and_b32 v126, s52, v30
    v_lshlrev_b32 v123, 16, v31
    v_and_b32 v127, s52, v31
    v_lshlrev_b32 v128, 16, v32
    v_and_b32 v129, s52, v32
    v_lshlrev_b32 v150, 16, v33
    v_and_b32 v154, s52, v33
    v_lshlrev_b32 v151, 16, v34
    v_and_b32 v155, s52, v34
    v_lshlrev_b32 v152, 16, v35
    v_and_b32 v156, s52, v35
    v_lshlrev_b32 v153, 16, v36
    v_and_b32 v157, s52, v36
    v_lshlrev_b32 v158, 16, v37
    v_and_b32 v159, s52, v37
    v_lshlrev_b32 v140, 16, v38
    v_and_b32 v144, s52, v38
    v_lshlrev_b32 v141, 16, v39
    v_and_b32 v145, s52, v39
    v_lshlrev_b32 v142, 16, v40
    v_and_b32 v146, s52, v40
    v_lshlrev_b32 v143, 16, v41
    v_and_b32 v147, s52, v41
    v_lshlrev_b32 v148, 16, v42
    v_and_b32 v149, s52, v42
    v_lshlrev_b32 v130, 16, v48
    v_and_b32 v134, s52, v48
    v_lshlrev_b32 v131, 16, v49
    v_and_b32 v135, s52, v49
    v_lshlrev_b32 v132, 16, v50
    v_and_b32 v136, s52, v50
    v_lshlrev_b32 v133, 16, v51
    v_and_b32 v137, s52, v51
    v_lshlrev_b32 v138, 16, v52
    v_and_b32 v139, s52, v52
    v_lshlrev_b32 v28, 16, v43
    v_and_b32 v32, s52, v43
    v_lshlrev_b32 v29, 16, v44
    v_and_b32 v33, s52, v44
    v_lshlrev_b32 v30, 16, v45
    v_and_b32 v34, s52, v45
    v_lshlrev_b32 v31, 16, v46
    v_and_b32 v35, s52, v46
    v_lshlrev_b32 v36, 16, v47
    v_and_b32 v37, s52, v47
    v_pk_mul_f32 v[54:55], v[130:131], v[150:151]
    v_pk_fma_f32 v[54:55], v[132:133], v[152:153], v[54:55]
    v_pk_fma_f32 v[54:55], v[134:135], v[154:155], v[54:55]
    v_pk_fma_f32 v[54:55], v[136:137], v[156:157], v[54:55]
    v_pk_fma_f32 v[54:55], v[138:139], v[158:159], v[54:55]
    v_add_f32 v54, v54, v55
    v_pk_mul_f32 v[130:131], v[130:131], v[140:141]
    v_pk_mul_f32 v[132:133], v[132:133], v[142:143]
    v_pk_mul_f32 v[134:135], v[134:135], v[144:145]
    v_pk_mul_f32 v[136:137], v[136:137], v[146:147]
    v_pk_mul_f32 v[138:139], v[138:139], v[148:149]
    v_pk_add_f32 v[56:57], v[130:131], v[132:133]
    v_pk_add_f32 v[56:57], v[56:57], v[134:135]
    v_pk_add_f32 v[56:57], v[56:57], v[136:137]
    v_pk_add_f32 v[56:57], v[56:57], v[138:139]
    v_add_f32 v56, v56, v57
    v_mov_b32 v58, s41
    v_pk_mul_f32 v[140:141], v[140:141], v[28:29]
    v_pk_fma_f32 v[150:151], v[150:151], v[28:29], v[58:59] op_sel:[0,0,0] op_sel_hi:[1,1,0]
    v_pk_mul_f32 v[142:143], v[142:143], v[30:31]
    v_pk_fma_f32 v[152:153], v[152:153], v[30:31], v[58:59] op_sel:[0,0,0] op_sel_hi:[1,1,0]
    v_pk_mul_f32 v[144:145], v[144:145], v[32:33]
    v_pk_fma_f32 v[154:155], v[154:155], v[32:33], v[58:59] op_sel:[0,0,0] op_sel_hi:[1,1,0]
    v_pk_mul_f32 v[146:147], v[146:147], v[34:35]
    v_pk_fma_f32 v[156:157], v[156:157], v[34:35], v[58:59] op_sel:[0,0,0] op_sel_hi:[1,1,0]
    v_pk_mul_f32 v[148:149], v[148:149], v[36:37]
    v_pk_fma_f32 v[158:159], v[158:159], v[36:37], v[58:59] op_sel:[0,0,0] op_sel_hi:[1,1,0]
    v_add_f32_dpp v56, v56, v56 row_ror:8 row_mask:0xf bank_mask:0xf
    v_add_f32_dpp v54, v54, v54 row_ror:8 row_mask:0xf bank_mask:0xf
    s_nop 0
    v_add_f32_dpp v56, v56, v56 row_ror:4 row_mask:0xf bank_mask:0xf
    v_add_f32_dpp v54, v54, v54 row_ror:4 row_mask:0xf bank_mask:0xf
    s_nop 0
    v_add_f32_dpp v56, v56, v56 row_ror:2 row_mask:0xf bank_mask:0xf
    v_add_f32_dpp v54, v54, v54 row_ror:2 row_mask:0xf bank_mask:0xf
    s_nop 0
    v_add_f32_dpp v56, v56, v56 row_ror:1 row_mask:0xf bank_mask:0xf
    v_add_f32_dpp v54, v54, v54 row_ror:1 row_mask:0xf bank_mask:0xf
    s_nop 0
    v_add_f32_dpp v56, v56, v56 row_bcast:15 row_mask:0xa bank_mask:0xf
    v_add_f32_dpp v54, v54, v54 row_bcast:15 row_mask:0xa bank_mask:0xf
    s_nop 0
    v_add_f32_dpp v56, v56, v56 row_bcast:31 row_mask:0xc bank_mask:0xf
    v_add_f32_dpp v54, v54, v54 row_bcast:31 row_mask:0xc bank_mask:0xf
    v_readlane_b32 s50, v56, 63
    v_readlane_b32 s51, v54, 63
    s_cmp_ge_u32 s5, 22
    s_cbranch_scc0 L_nob5c
    s_barrier
L_nob5c:
    s_cmp_ge_u32 s3, 6
    s_cbranch_scc1 L_b6
    s_mov_b64 exec, s[64:65]
    global_load_dwordx4 v[20:23], v5, s[34:35] sc1
    global_load_dwordx4 v[24:27], v5, s[36:37] sc1
    s_mov_b64 exec, -1
    s_mov_b32 s40, 1000000
    s_waitcnt vmcnt(0)
L_pollc_12:
    v_cmp_ne_u32 vcc, s55, v23
    v_cmp_ne_u32 s[38:39], s55, v27
    s_nop 0
    s_or_b64 vcc, vcc, s[38:39]
    s_and_b64 vcc, vcc, s[62:63]
    s_cbranch_scc1 L_poll_10
L_polld_11:
    v_swap_b32 v21, v24
    v_swap_b32 v23, v26
    s_nop 0
    v_mfma_f32_16x16x16_bf16 v[36:39], v[8:9], v[20:21], 0
    v_mfma_f32_16x16x16_bf16 v[40:43], v[8:9], v[24:25], 0
    v_mfma_f32_16x16x16_bf16 v[44:47], v[8:9], v[22:23], 0
    v_mfma_f32_16x16x16_bf16 v[48:51], v[8:9], v[26:27], 0
    s_nop 4
    v_cvt_pk_bf16_f32 v28, v37, v36
    v_cvt_pk_bf16_f32 v29, v39, v38
    ds_write_b64 v165, v[28:29] offset:0
    v_cvt_pk_bf16_f32 v30, v41, v40
    v_cvt_pk_bf16_f32 v31, v43, v42
    ds_write_b64 v165, v[30:31] offset:8
    v_cvt_pk_bf16_f32 v32, v45, v44
    v_cvt_pk_bf16_f32 v33, v47, v46
    ds_write_b64 v165, v[32:33] offset:16
    v_cvt_pk_bf16_f32 v34, v49, v48
    v_cvt_pk_bf16_f32 v35, v51, v50
    ds_write_b64 v7, v[34:35] offset:24
    s_waitcnt lgkmcnt(0)
L_b6:
    s_barrier
    ds_read2_b32 v[28:29], v161 offset0:0 offset1:80
    ds_read2_b32 v[30:31], v161 offset0:160 offset1:240
    ds_read2_b32 v[32:33], v162 offset0:0 offset1:80
    ds_read2_b32 v[34:35], v162 offset0:160 offset1:240
    s_waitcnt lgkmcnt(2)
    v_mfma_f32_16x16x32_bf16 v[36:39], v[28:31], v[68:71], 0
    v_mfma_f32_16x16x32_bf16 v[40:43], v[28:31], v[60:63], 0
    v_mfma_f32_16x16x32_bf16 v[44:47], v[28:31], v[84:87], 0
    v_mfma_f32_16x16x32_bf16 v[48:51], v[28:31], v[76:79], 0
    s_waitcnt lgkmcnt(0)
    v_mfma_f32_16x16x32_bf16 v[36:39], v[32:35], v[72:75], v[36:39]
    v_mfma_f32_16x16x32_bf16 v[40:43], v[32:35], v[64:67], v[40:43]
    v_mfma_f32_16x16x32_bf16 v[44:47], v[32:35], v[88:91], v[44:47]
    v_mfma_f32_16x16x32_bf16 v[48:51], v[32:35], v[80:83], v[48:51]
    s_nop 4
    v_mul_f32 v20, v36, v92
    v_mul_f32 v21, v37, v93
    v_mul_f32 v22, v38, v94
    v_mul_f32 v24, v40, v92
    v_mul_f32 v25, v41, v93
    v_mul_f32 v26, v42, v94
    v_fma_f32 v20, -v40, v96, v20
    v_fmac_f32 v24, v36, v96
    v_fma_f32 v21, -v41, v97, v21
    v_fmac_f32 v25, v37, v97
    v_fma_f32 v22, -v42, v98, v22
    v_fmac_f32 v26, v38, v98
    v_cvt_pk_bf16_f32 v28, v20, v24
    v_cvt_pk_bf16_f32 v29, v21, v25
    v_cvt_pk_bf16_f32 v30, v22, v26
    v_mov_b32 v31, 0
    v_mul_f32 v52, v44, v100
    v_mul_f32 v53, v45, v101
    v_mul_f32 v54, v46, v102
    v_mul_f32 v56, v48, v100
    v_mul_f32 v57, v49, v101
    v_mul_f32 v58, v50, v102
    v_fma_f32 v52, -v48, v104, v52
    v_fmac_f32 v56, v44, v104
    v_fma_f32 v53, -v49, v105, v53
    v_fmac_f32 v57, v45, v105
    v_fma_f32 v54, -v50, v106, v54
    v_fmac_f32 v58, v46, v106
    v_cvt_pk_bf16_f32 v32, v52, v56
    v_cvt_pk_bf16_f32 v33, v53, v57
    v_cvt_pk_bf16_f32 v34, v54, v58
    v_mov_b32 v35, 0
    v_mfma_f32_16x16x32_bf16 v[36:39], v[108:111], v[28:31], 0
    v_mfma_f32_16x16x32_bf16 v[44:47], v[112:115], v[28:31], 0
    v_mfma_f32_16x16x32_bf16 v[40:43], v[108:111], v[32:35], 0
    v_mfma_f32_16x16x32_bf16 v[44:47], v[116:119], v[32:35], v[44:47]
    s_nop 4
    v_pk_fma_f32 v[10:11], v[36:37], v[120:121], v[10:11]
    v_pk_fma_f32 v[12:13], v[38:39], v[122:123], v[12:13]
    v_pk_fma_f32 v[14:15], v[40:41], v[124:125], v[14:15]
    v_pk_fma_f32 v[16:17], v[42:43], v[126:127], v[16:17]
    v_pk_fma_f32 v[18:19], v[44:45], v[128:129], v[18:19]
    v_pk_mul_f32 v[56:57], v[10:11], v[130:131]
    v_pk_add_f32 v[52:53], v[10:11], v[12:13]
    v_pk_mul_f32 v[54:55], v[10:11], v[10:11]
    v_pk_fma_f32 v[56:57], v[12:13], v[132:133], v[56:57]
    v_pk_fma_f32 v[54:55], v[12:13], v[12:13], v[54:55]
    v_pk_fma_f32 v[56:57], v[14:15], v[134:135], v[56:57]
    v_pk_add_f32 v[52:53], v[52:53], v[14:15]
    v_pk_fma_f32 v[54:55], v[14:15], v[14:15], v[54:55]
    v_pk_fma_f32 v[56:57], v[16:17], v[136:137], v[56:57]
    v_pk_add_f32 v[52:53], v[52:53], v[16:17]
    v_pk_fma_f32 v[54:55], v[16:17], v[16:17], v[54:55]
    v_pk_fma_f32 v[56:57], v[18:19], v[138:139], v[56:57]
    v_pk_add_f32 v[52:53], v[52:53], v[18:19]
    v_pk_fma_f32 v[54:55], v[18:19], v[18:19], v[54:55]
    v_add_f32 v22, v56, v57
    v_add_f32 v20, v52, v53
    v_add_f32 v21, v54, v55
    v_permlane32_swap_b32 v22, v23
    s_nop 0
    v_permlane32_swap_b32 v20, v21
    v_add_f32 v22, v22, v23
    v_add_f32 v20, v20, v21
    s_nop 1
    v_permlane16_swap_b32 v20, v22
    v_add_f32 v20, v20, v22
    s_nop 1
    v_add_f32_dpp v20, v20, v20 row_ror:8 row_mask:0xf bank_mask:0xf
    s_nop 1
    v_add_f32_dpp v20, v20, v20 row_ror:4 row_mask:0xf bank_mask:0xf
    s_nop 1
    v_add_f32_dpp v20, v20, v20 row_ror:2 row_mask:0xf bank_mask:0xf
    s_nop 1
    v_add_f32_dpp v20, v20, v20 row_ror:1 row_mask:0xf bank_mask:0xf
    s_nop 0
    v_readlane_b32 s42, v20, 0
    v_readlane_b32 s46, v20, 32
    v_readlane_b32 s47, v20, 16
    v_mul_f32 v23, s42, v167
    v_fma_f32 v52, v23, v23, v6
    v_mov_b32 v24, s47
    v_fmac_f32 v52, s46, v167
    v_fmac_f32 v24, s50, v23
    v_sub_f32 v22, v6, v52
    v_rsq_f32_e64 v52, -v52
    v_mov_b32 v27, s55
    s_mov_b64 exec, 1
    v_fma_f32 v24, v24, v52, s51
    v_ashrrev_i32 v25, 31, v24
    v_or_b32 v25, 0x80000000, v25
    v_xor_b32 v24, v24, v25
    v_and_b32 v24, 0xfffff800, v24
    v_or_b32 v24, s49, v24
    ds_max_u32 v163, v24
    ds_add_rtn_u32 v25, v163, v164 offset:8
    ds_read_b32 v26, v163
    v_readfirstlane_b32 s49, v24
    s_waitcnt lgkmcnt(0)
    v_cmpx_eq_u32 vcc, 7, v25
    s_cbranch_execz L_notlast
    global_store_dwordx2 v3, v[26:27], s[56:57] sc1
L_notlast:
    s_mov_b64 exec, -1
    s_barrier
    ds_read_b32 v26, v163
    v_sub_f32 v23, s41, v23
    v_cvt_pk_bf16_f32 v23, v23, v23
    v_and_b32 v23, s52, v23
    v_cvt_pk_bf16_f32 v52, v22, v22
    v_and_b32 v52, s52, v52
    v_add_f32 v52, 0x3727c5ac, v52
    v_cvt_pk_bf16_f32 v52, v52, v52
    v_and_b32 v52, s52, v52
    v_sqrt_f32 v52, v52
    s_nop 0
    v_cvt_pk_bf16_f32 v52, v52, v52
    v_and_b32 v52, s52, v52
    v_rcp_f32 v52, v52
    v_sub_f32 v23, s41, v23
    v_mul_f32 v53, v23, v52
    v_pk_fma_f32 v[120:121], v[10:11], v[52:53], v[52:53] op_sel:[0,0,1] op_sel_hi:[1,0,1]
    v_pk_fma_f32 v[122:123], v[12:13], v[52:53], v[52:53] op_sel:[0,0,1] op_sel_hi:[1,0,1]
    v_pk_fma_f32 v[124:125], v[14:15], v[52:53], v[52:53] op_sel:[0,0,1] op_sel_hi:[1,0,1]
    v_pk_fma_f32 v[126:127], v[16:17], v[52:53], v[52:53] op_sel:[0,0,1] op_sel_hi:[1,0,1]
    v_pk_fma_f32 v[128:129], v[18:19], v[52:53], v[52:53] op_sel:[0,0,1] op_sel_hi:[1,0,1]
    s_waitcnt lgkmcnt(0)
    v_readfirstlane_b32 s42, v26
    s_nop 0
    s_cmp_eq_u32 s42, s49
    s_cselect_b32 s53, 1, 0
    s_cbranch_scc1 L_cand
    v_pk_add_f32 v[36:37], v[10:11], v[150:151]
    v_pk_add_f32 v[38:39], v[12:13], v[152:153]
    v_pk_add_f32 v[40:41], v[14:15], v[154:155]
    v_pk_add_f32 v[42:43], v[16:17], v[156:157]
    v_pk_add_f32 v[44:45], v[18:19], v[158:159]
    v_pk_fma_f32 v[36:37], v[120:121], v[140:141], v[36:37]
    v_pk_fma_f32 v[38:39], v[122:123], v[142:143], v[38:39]
    v_pk_fma_f32 v[40:41], v[124:125], v[144:145], v[40:41]
    v_pk_fma_f32 v[42:43], v[126:127], v[146:147], v[42:43]
    v_pk_fma_f32 v[44:45], v[128:129], v[148:149], v[44:45]
    v_cvt_pk_bf16_f32 v10, v36, v40
    v_cvt_pk_bf16_f32 v11, v37, v41
    v_cvt_pk_bf16_f32 v12, v38, v42
    v_cvt_pk_bf16_f32 v13, v39, v43
    v_cvt_pk_bf16_f32 v14, v44, v45
    s_branch L_keys
L_cand:
    ds_read2st64_b32 v[60:61], v166 offset0:5 offset1:6
    ds_read2st64_b32 v[62:63], v166 offset0:7 offset1:8
    ds_read2st64_b32 v[64:65], v166 offset0:9 offset1:10
    ds_read2st64_b32 v[66:67], v166 offset0:11 offset1:12
    ds_read2st64_b32 v[68:69], v166 offset0:13 offset1:14
    v_mov_b32 v95, s55
    v_mov_b32 v99, s55
    s_waitcnt lgkmcnt(0)
    v_lshlrev_b32 v70, 16, v60
    v_and_b32 v74, s52, v60
    v_lshlrev_b32 v80, 16, v65
    v_and_b32 v84, s52, v65
    v_lshlrev_b32 v71, 16, v61
    v_and_b32 v75, s52, v61
    v_lshlrev_b32 v81, 16, v66
    v_and_b32 v85, s52, v66
    v_lshlrev_b32 v72, 16, v62
    v_and_b32 v76, s52, v62
    v_lshlrev_b32 v82, 16, v67
    v_and_b32 v86, s52, v67
    v_lshlrev_b32 v73, 16, v63
    v_and_b32 v77, s52, v63
    v_lshlrev_b32 v83, 16, v68
    v_and_b32 v87, s52, v68
    v_lshlrev_b32 v78, 16, v64
    v_and_b32 v79, s52, v64
    v_lshlrev_b32 v88, 16, v69
    v_and_b32 v89, s52, v69
    v_pk_fma_f32 v[70:71], v[120:121], v[80:81], v[70:71]
    v_pk_fma_f32 v[72:73], v[122:123], v[82:83], v[72:73]
    v_pk_fma_f32 v[74:75], v[124:125], v[84:85], v[74:75]
    v_pk_fma_f32 v[76:77], v[126:127], v[86:87], v[76:77]
    v_pk_fma_f32 v[78:79], v[128:129], v[88:89], v[78:79]
    v_cvt_pk_bf16_f32 v92, v70, v74
    v_cvt_pk_bf16_f32 v93, v71, v75
    v_cvt_pk_bf16_f32 v94, v72, v76
    v_cvt_pk_bf16_f32 v96, v73, v77
    v_cvt_pk_bf16_f32 v97, v78, v79
    global_store_dwordx4 v2, v[92:95], s[56:57] offset:128 sc1
    global_store_dwordx4 v2, v[96:99], s[56:57] offset:1152 sc1
    v_pk_add_f32 v[36:37], v[10:11], v[150:151]
    v_pk_add_f32 v[38:39], v[12:13], v[152:153]
    v_pk_add_f32 v[40:41], v[14:15], v[154:155]
    v_pk_add_f32 v[42:43], v[16:17], v[156:157]
    v_pk_add_f32 v[44:45], v[18:19], v[158:159]
    v_pk_fma_f32 v[36:37], v[120:121], v[140:141], v[36:37]
    v_pk_fma_f32 v[38:39], v[122:123], v[142:143], v[38:39]
    v_pk_fma_f32 v[40:41], v[124:125], v[144:145], v[40:41]
    v_pk_fma_f32 v[42:43], v[126:127], v[146:147], v[42:43]
    v_pk_fma_f32 v[44:45], v[128:129], v[148:149], v[44:45]
    v_cvt_pk_bf16_f32 v10, v36, v40
    v_cvt_pk_bf16_f32 v11, v37, v41
    v_cvt_pk_bf16_f32 v12, v38, v42
    v_cvt_pk_bf16_f32 v13, v39, v43
    v_cvt_pk_bf16_f32 v14, v44, v45
L_keys:
    global_store_dword v3, v10, s[72:73] offset:0 sc1
    global_store_dword v3, v11, s[72:73] offset:256 sc1
    global_store_dword v3, v12, s[72:73] offset:512 sc1
    global_store_dword v3, v13, s[72:73] offset:768 sc1
    global_store_dword v3, v14, s[72:73] offset:1024 sc1
    s_barrier
    s_cmp_lt_u32 s5, 20
    s_cbranch_scc1 L_no_ew
    s_mul_i32 s7, s3, 5120
    s_add_u32 s7, s7, 89664
    v_and_b32 v28, 0x3c0, v2
    v_and_b32 v29, 24, v160
    v_add3_u32 v28, v28, v29, s7
    s_mul_i32 s7, s3, 320
    s_add_u32 s7, s7, 130624
    v_min_u32 v161, 312, v160
    v_add_u32 v161, s7, v161
    ds_read2_b64 v[68:71], v28 offset0:0 offset1:4
    ds_read2_b64 v[72:75], v28 offset0:128 offset1:132
    v_add_u32 v28, 2048, v28
    ds_read2_b64 v[76:79], v28 offset0:0 offset1:4
    ds_read2_b64 v[80:83], v28 offset0:128 offset1:132
    v_add_u32 v28, 2048, v28
    ds_read2_b64 v[84:87], v28 offset0:0 offset1:4
    v_and_b32 v15, 3, v1
    v_lshlrev_b32 v15, 6, v15
    v_and_b32 v16, 48, v1
    v_add_u32 v15, v16, v15
    s_lshr_b32 s43, s3, 2
    s_lshl_b32 s43, s43, 8
    s_and_b32 s7, s3, 3
    s_lshl_b32 s7, s7, 2
    s_add_u32 s43, s43, s7
    s_add_u32 s43, s43, 26624
    v_add_u32 v15, s43, v15
    v_and_b32 v16, 0xf0, v2
    v_bfe_u32 v17, v0, 2, 6
    v_lshlrev_b32 v17, 4, v17
    s_mov_b32 s46, 0x05040100
    s_mov_b32 s47, 0x07060302
    v_add_u32 v17, 524416, v17
    v_mov_b32 v18, 0xffffff00
    s_mul_i32 s43, s4, 12
    s_add_u32 s43, s43, s5
    s_mul_i32 s43, s43, 2688
    s_mul_i32 s7, s3, 640
    s_add_u32 s43, s43, s7
    s_add_u32 s7, s43, 77312
    s_add_u32 s36, s32, s7
    s_addc_u32 s37, s33, 0
    s_waitcnt lgkmcnt(0)
    v_perm_b32 v48, v70, v68, s46
    v_perm_b32 v49, v70, v68, s47
    v_perm_b32 v50, v71, v69, s46
    v_perm_b32 v51, v71, v69, s47
    v_perm_b32 v52, v74, v72, s46
    v_perm_b32 v53, v74, v72, s47
    v_perm_b32 v54, v75, v73, s46
    v_perm_b32 v55, v75, v73, s47
    v_perm_b32 v56, v78, v76, s46
    v_perm_b32 v57, v78, v76, s47
    v_perm_b32 v58, v79, v77, s46
    v_perm_b32 v59, v79, v77, s47
    v_perm_b32 v60, v82, v80, s46
    v_perm_b32 v61, v82, v80, s47
    v_perm_b32 v62, v83, v81, s46
    v_perm_b32 v63, v83, v81, s47
    v_perm_b32 v64, v86, v84, s46
    v_perm_b32 v65, v86, v84, s47
    v_perm_b32 v66, v87, v85, s46
    v_perm_b32 v67, v87, v85, s47
    v_mov_b32 v36, 0
    v_mov_b32 v37, 0
    v_mov_b32 v38, 0
    v_mov_b32 v39, 0
    s_cmp_ge_u32 s3, 4
    s_cbranch_scc1 L_no_fw
    ds_read_b64 v[120:121], v161 offset:0
    ds_read_b64 v[122:123], v161 offset:1280
    ds_read_b64 v[124:125], v161 offset:2560
    ds_read_b64 v[126:127], v161 offset:3840
    ds_read_b64 v[128:129], v161 offset:5120
    ds_read_b64 v[130:131], v161 offset:6400
    ds_read_b64 v[132:133], v161 offset:7680
    ds_read_b64 v[134:135], v161 offset:8960
    s_waitcnt lgkmcnt(0)
    ds_read_b64 v[136:137], v161 offset:10240
    ds_read_b64 v[138:139], v161 offset:11520
    ds_read_b64 v[140:141], v161 offset:12800
    ds_read_b64 v[142:143], v161 offset:14080
    ds_read_b64 v[144:145], v161 offset:15360
    ds_read_b64 v[146:147], v161 offset:16640
    ds_read_b64 v[148:149], v161 offset:17920
    ds_read_b64 v[150:151], v161 offset:19200
    s_waitcnt lgkmcnt(0)
    v_lshlrev_b32 v88, 16, v120
    v_and_b32 v89, s52, v120
    v_lshlrev_b32 v90, 16, v121
    v_and_b32 v91, s52, v121
    v_lshlrev_b32 v92, 16, v122
    v_and_b32 v93, s52, v122
    v_lshlrev_b32 v94, 16, v123
    v_and_b32 v95, s52, v123
    v_lshlrev_b32 v96, 16, v124
    v_and_b32 v97, s52, v124
    v_lshlrev_b32 v98, 16, v125
    v_and_b32 v99, s52, v125
    v_lshlrev_b32 v100, 16, v126
    v_and_b32 v101, s52, v126
    v_lshlrev_b32 v102, 16, v127
    v_and_b32 v103, s52, v127
    v_lshlrev_b32 v104, 16, v128
    v_and_b32 v105, s52, v128
    v_lshlrev_b32 v106, 16, v129
    v_and_b32 v107, s52, v129
    v_lshlrev_b32 v108, 16, v130
    v_and_b32 v109, s52, v130
    v_lshlrev_b32 v110, 16, v131
    v_and_b32 v111, s52, v131
    v_lshlrev_b32 v112, 16, v132
    v_and_b32 v113, s52, v132
    v_lshlrev_b32 v114, 16, v133
    v_and_b32 v115, s52, v133
    v_lshlrev_b32 v116, 16, v134
    v_and_b32 v117, s52, v134
    v_lshlrev_b32 v118, 16, v135
    v_and_b32 v119, s52, v135
    v_lshlrev_b32 v120, 16, v136
    v_and_b32 v121, s52, v136
    v_lshlrev_b32 v122, 16, v137
    v_and_b32 v123, s52, v137
    v_lshlrev_b32 v124, 16, v138
    v_and_b32 v125, s52, v138
    v_lshlrev_b32 v126, 16, v139
    v_and_b32 v127, s52, v139
    v_lshlrev_b32 v128, 16, v140
    v_and_b32 v129, s52, v140
    v_lshlrev_b32 v130, 16, v141
    v_and_b32 v131, s52, v141
    v_lshlrev_b32 v132, 16, v142
    v_and_b32 v133, s52, v142
    v_lshlrev_b32 v134, 16, v143
    v_and_b32 v135, s52, v143
    v_lshlrev_b32 v136, 16, v144
    v_and_b32 v137, s52, v144
    v_lshlrev_b32 v138, 16, v145
    v_and_b32 v139, s52, v145
    v_lshlrev_b32 v140, 16, v146
    v_and_b32 v141, s52, v146
    v_lshlrev_b32 v142, 16, v147
    v_and_b32 v143, s52, v147
    v_lshlrev_b32 v144, 16, v148
    v_and_b32 v145, s52, v148
    v_lshlrev_b32 v146, 16, v149
    v_and_b32 v147, s52, v149
    v_lshlrev_b32 v148, 16, v150
    v_and_b32 v149, s52, v150
    v_lshlrev_b32 v150, 16, v151
    v_and_b32 v151, s52, v151
L_no_fw:
L_no_ew:
    s_cmp_eq_u32 s53, 0
    s_cbranch_scc1 L_nobase
    v_mov_b32 v40, v10
    v_mov_b32 v41, v11
    v_mov_b32 v42, v12
    v_mov_b32 v43, s55
    v_mov_b32 v44, v13
    v_mov_b32 v45, v14
    v_mov_b32 v47, s55
    s_waitcnt vmcnt(0)
    global_store_dwordx4 v2, v[40:43], s[56:57] offset:2176 sc1
    global_store_dwordx4 v2, v[44:47], s[56:57] offset:3200 sc1
L_nobase:
    s_cmp_lt_u32 s5, 20
    s_cbranch_scc1 L_fin
    v_mov_b32 v30, 28676
L_b8:
    s_barrier
    ds_read_b32 v31, v30
    s_movk_i32 s7, 4224
    s_waitcnt lgkmcnt(0)
    v_and_b32 v32, 255, v31
    v_mad_u32_u24 v17, v32, s7, v17
    global_load_dwordx4 v[20:23], v17, s[32:33] sc1
    global_load_dwordx4 v[24:27], v17, s[32:33] offset:1024 sc1
    s_mov_b32 s40, 1000000
    s_waitcnt vmcnt(0)
L_pollc_15:
    v_xor_b32 v30, v23, v27
    v_xor_b32 v32, s55, v23
    v_or_b32 v30, v30, v32
    v_cmpx_ne_u32 vcc, 0, v30
    s_cbranch_execnz L_poll_13
L_polld_14:
    s_mov_b64 exec, -1
    v_dot2c_f32_bf16 v36, v48, v20
    v_dot2c_f32_bf16 v38, v50, v20
    v_dot2c_f32_bf16 v37, v49, v20
    v_dot2c_f32_bf16 v39, v51, v20
    v_dot2c_f32_bf16 v36, v52, v21
    v_dot2c_f32_bf16 v38, v54, v21
    v_dot2c_f32_bf16 v37, v53, v21
    v_dot2c_f32_bf16 v39, v55, v21
    v_dot2c_f32_bf16 v36, v56, v22
    v_dot2c_f32_bf16 v38, v58, v22
    v_dot2c_f32_bf16 v37, v57, v22
    v_dot2c_f32_bf16 v39, v59, v22
    v_dot2c_f32_bf16 v36, v60, v24
    v_dot2c_f32_bf16 v38, v62, v24
    v_dot2c_f32_bf16 v37, v61, v24
    v_dot2c_f32_bf16 v39, v63, v24
    v_dot2c_f32_bf16 v36, v64, v25
    v_dot2c_f32_bf16 v38, v66, v25
    v_dot2c_f32_bf16 v37, v65, v25
    v_dot2c_f32_bf16 v39, v67, v25
    s_nop 0
    v_permlane32_swap_b32 v36, v38
    s_nop 0
    v_permlane32_swap_b32 v37, v39
    v_pk_add_f32 v[36:37], v[36:37], v[38:39]
    s_nop 1
    v_permlane16_swap_b32 v36, v37
    v_add_f32 v36, v36, v37
    s_nop 1
    v_add_f32_dpp v36, v36, v36 row_ror:8 row_mask:0xf bank_mask:0xf
    s_nop 1
    v_add_f32_dpp v36, v36, v36 row_ror:4 row_mask:0xf bank_mask:0xf
    s_mov_b32 exec_lo, 0x000f000f
    s_mov_b32 exec_hi, 0x000f000f
    ds_write_b32 v15, v36
    s_mov_b64 exec, -1
    s_cmp_ge_u32 s3, 4
    s_waitcnt lgkmcnt(0)
    s_barrier
    s_cbranch_scc1 L_e_done
    ds_read_b128 v[20:23], v16 offset:26624
    ds_read_b128 v[24:27], v16 offset:26880
    s_waitcnt lgkmcnt(0)
    v_pk_add_f32 v[20:21], v[20:21], v[22:23]
    v_pk_add_f32 v[24:25], v[24:25], v[26:27]
    v_add_f32 v20, v20, v21
    v_add_f32 v24, v24, v25
    v_mul_f32 v21, 0xbfb8aa3b, v20
    v_exp_f32 v21, v21
    v_mul_f32 v20, v20, v24
    v_add_f32 v21, 1.0, v21
    v_rcp_f32 v21, v21
    s_nop 0
    v_mul_f32 v20, v20, v21
    s_nop 0
    v_readlane_b32 s8, v20, 0
    v_readlane_b32 s9, v20, 1
    v_readlane_b32 s10, v20, 2
    v_readlane_b32 s11, v20, 3
    v_readlane_b32 s12, v20, 4
    v_readlane_b32 s13, v20, 5
    v_readlane_b32 s14, v20, 6
    v_readlane_b32 s15, v20, 7
    v_readlane_b32 s16, v20, 8
    v_readlane_b32 s17, v20, 9
    v_readlane_b32 s18, v20, 10
    v_readlane_b32 s19, v20, 11
    v_readlane_b32 s20, v20, 12
    v_readlane_b32 s21, v20, 13
    v_readlane_b32 s22, v20, 14
    v_readlane_b32 s23, v20, 15
    v_pk_mul_f32 v[36:37], v[88:89], s[8:9] op_sel:[0,0] op_sel_hi:[1,0]
    v_pk_mul_f32 v[38:39], v[90:91], s[8:9] op_sel:[0,0] op_sel_hi:[1,0]
    v_pk_fma_f32 v[36:37], v[92:93], s[8:9], v[36:37] op_sel:[0,1,0] op_sel_hi:[1,1,1]
    v_pk_fma_f32 v[38:39], v[94:95], s[8:9], v[38:39] op_sel:[0,1,0] op_sel_hi:[1,1,1]
    v_pk_fma_f32 v[36:37], v[96:97], s[10:11], v[36:37] op_sel:[0,0,0] op_sel_hi:[1,0,1]
    v_pk_fma_f32 v[38:39], v[98:99], s[10:11], v[38:39] op_sel:[0,0,0] op_sel_hi:[1,0,1]
    v_pk_fma_f32 v[36:37], v[100:101], s[10:11], v[36:37] op_sel:[0,1,0] op_sel_hi:[1,1,1]
    v_pk_fma_f32 v[38:39], v[102:103], s[10:11], v[38:39] op_sel:[0,1,0] op_sel_hi:[1,1,1]
    v_pk_fma_f32 v[36:37], v[104:105], s[12:13], v[36:37] op_sel:[0,0,0] op_sel_hi:[1,0,1]
    v_pk_fma_f32 v[38:39], v[106:107], s[12:13], v[38:39] op_sel:[0,0,0] op_sel_hi:[1,0,1]
    v_pk_fma_f32 v[36:37], v[108:109], s[12:13], v[36:37] op_sel:[0,1,0] op_sel_hi:[1,1,1]
    v_pk_fma_f32 v[38:39], v[110:111], s[12:13], v[38:39] op_sel:[0,1,0] op_sel_hi:[1,1,1]
    v_pk_fma_f32 v[36:37], v[112:113], s[14:15], v[36:37] op_sel:[0,0,0] op_sel_hi:[1,0,1]
    v_pk_fma_f32 v[38:39], v[114:115], s[14:15], v[38:39] op_sel:[0,0,0] op_sel_hi:[1,0,1]
    v_pk_fma_f32 v[36:37], v[116:117], s[14:15], v[36:37] op_sel:[0,1,0] op_sel_hi:[1,1,1]
    v_pk_fma_f32 v[38:39], v[118:119], s[14:15], v[38:39] op_sel:[0,1,0] op_sel_hi:[1,1,1]
    v_pk_fma_f32 v[36:37], v[120:121], s[16:17], v[36:37] op_sel:[0,0,0] op_sel_hi:[1,0,1]
    v_pk_fma_f32 v[38:39], v[122:123], s[16:17], v[38:39] op_sel:[0,0,0] op_sel_hi:[1,0,1]
    v_pk_fma_f32 v[36:37], v[124:125], s[16:17], v[36:37] op_sel:[0,1,0] op_sel_hi:[1,1,1]
    v_pk_fma_f32 v[38:39], v[126:127], s[16:17], v[38:39] op_sel:[0,1,0] op_sel_hi:[1,1,1]
    v_pk_fma_f32 v[36:37], v[128:129], s[18:19], v[36:37] op_sel:[0,0,0] op_sel_hi:[1,0,1]
    v_pk_fma_f32 v[38:39], v[130:131], s[18:19], v[38:39] op_sel:[0,0,0] op_sel_hi:[1,0,1]
    v_pk_fma_f32 v[36:37], v[132:133], s[18:19], v[36:37] op_sel:[0,1,0] op_sel_hi:[1,1,1]
    v_pk_fma_f32 v[38:39], v[134:135], s[18:19], v[38:39] op_sel:[0,1,0] op_sel_hi:[1,1,1]
    v_pk_fma_f32 v[36:37], v[136:137], s[20:21], v[36:37] op_sel:[0,0,0] op_sel_hi:[1,0,1]
    v_pk_fma_f32 v[38:39], v[138:139], s[20:21], v[38:39] op_sel:[0,0,0] op_sel_hi:[1,0,1]
    v_pk_fma_f32 v[36:37], v[140:141], s[20:21], v[36:37] op_sel:[0,1,0] op_sel_hi:[1,1,1]
    v_pk_fma_f32 v[38:39], v[142:143], s[20:21], v[38:39] op_sel:[0,1,0] op_sel_hi:[1,1,1]
    v_pk_fma_f32 v[36:37], v[144:145], s[22:23], v[36:37] op_sel:[0,0,0] op_sel_hi:[1,0,1]
    v_pk_fma_f32 v[38:39], v[146:147], s[22:23], v[38:39] op_sel:[0,0,0] op_sel_hi:[1,0,1]
    v_pk_fma_f32 v[36:37], v[148:149], s[22:23], v[36:37] op_sel:[0,1,0] op_sel_hi:[1,1,1]
    v_pk_fma_f32 v[38:39], v[150:151], s[22:23], v[38:39] op_sel:[0,1,0] op_sel_hi:[1,1,1]
    v_and_or_b32 v36, v36, v18, s68
    v_and_or_b32 v37, v37, v18, s69
    v_and_or_b32 v38, v38, v18, s70
    v_and_or_b32 v39, v39, v18, s71
    s_mov_b32 exec_hi, 0xff
    global_store_dwordx4 v2, v[36:39], s[36:37] sc1
    s_mov_b64 exec, -1
    s_waitcnt vmcnt(0)
L_e_done:
    s_barrier
L_fin:
L_end:
    s_endpgm
L_poll_2:
    s_sub_u32 s40, s40, 1
    s_cbranch_scc1 L_polld_3
    global_load_dwordx4 v[36:39], v29, s[32:33] offset:0 sc1
    global_load_dwordx4 v[40:43], v29, s[32:33] offset:256 sc1
    global_load_dwordx4 v[44:47], v29, s[32:33] offset:512 sc1
    global_load_dwordx4 v[48:51], v29, s[32:33] offset:768 sc1
    s_waitcnt vmcnt(0)
    s_branch L_pollc_4
L_idle:
    s_barrier
    ds_read_b128 v[108:111], v2 offset:15360
    ds_read_b128 v[112:115], v2 offset:16384
    ds_read_b128 v[116:119], v2 offset:17408
    ds_read_b128 v[60:63], v2 offset:18432
    ds_read_b128 v[64:67], v2 offset:19456
    ds_read_b128 v[76:79], v2 offset:20480
    ds_read_b128 v[80:83], v2 offset:21504
    ds_read_b128 v[40:43], v2 offset:10240
    s_waitcnt lgkmcnt(0)
    v_alignbit_b32 v68, v60, v60, 16
    v_xor_b32 v68, v43, v68
    v_xor_b32 v60, v42, v60
    v_alignbit_b32 v69, v61, v61, 16
    v_xor_b32 v69, v43, v69
    v_xor_b32 v61, v42, v61
    v_alignbit_b32 v70, v62, v62, 16
    v_xor_b32 v70, v43, v70
    v_xor_b32 v62, v42, v62
    v_alignbit_b32 v71, v63, v63, 16
    v_xor_b32 v71, v43, v71
    v_xor_b32 v63, v42, v63
    v_alignbit_b32 v72, v64, v64, 16
    v_xor_b32 v72, v43, v72
    v_xor_b32 v64, v42, v64
    v_alignbit_b32 v73, v65, v65, 16
    v_xor_b32 v73, v43, v73
    v_xor_b32 v65, v42, v65
    v_alignbit_b32 v74, v66, v66, 16
    v_xor_b32 v74, v43, v74
    v_xor_b32 v66, v42, v66
    v_alignbit_b32 v75, v67, v67, 16
    v_xor_b32 v75, v43, v75
    v_xor_b32 v67, v42, v67
    v_alignbit_b32 v84, v76, v76, 16
    v_xor_b32 v84, v43, v84
    v_xor_b32 v76, v42, v76
    v_alignbit_b32 v85, v77, v77, 16
    v_xor_b32 v85, v43, v85
    v_xor_b32 v77, v42, v77
    v_alignbit_b32 v86, v78, v78, 16
    v_xor_b32 v86, v43, v86
    v_xor_b32 v78, v42, v78
    v_alignbit_b32 v87, v79, v79, 16
    v_xor_b32 v87, v43, v87
    v_xor_b32 v79, v42, v79
    v_alignbit_b32 v88, v80, v80, 16
    v_xor_b32 v88, v43, v88
    v_xor_b32 v80, v42, v80
    v_alignbit_b32 v89, v81, v81, 16
    v_xor_b32 v89, v43, v89
    v_xor_b32 v81, v42, v81
    v_alignbit_b32 v90, v82, v82, 16
    v_xor_b32 v90, v43, v90
    v_xor_b32 v82, v42, v82
    v_alignbit_b32 v91, v83, v83, 16
    v_xor_b32 v91, v43, v91
    v_xor_b32 v83, v42, v83
    s_branch L_p3prep
L_poll_5:
    s_sub_u32 s40, s40, 1
    s_cbranch_scc1 L_polld_6
    s_lshr_b64 s[38:39], vcc, 1
    s_or_b64 vcc, vcc, s[38:39]
    s_lshr_b64 s[38:39], vcc, 2
    s_or_b64 exec, vcc, s[38:39]
    global_load_dwordx4 v[20:23], v5, s[34:35] sc1
    global_load_dwordx4 v[24:27], v5, s[36:37] sc1
    s_mov_b64 exec, -1
    s_waitcnt vmcnt(0)
    s_branch L_pollc_7
L_p2_one:
    ds_read2st64_b32 v[20:21], v163 offset0:0 offset1:5
    ds_read2st64_b32 v[22:23], v163 offset0:10 offset1:15
    s_waitcnt lgkmcnt(0)
    v_mfma_f32_16x16x32_bf16 v[36:39], v[20:23], v[92:95], 0
    v_mfma_f32_16x16x32_bf16 v[40:43], v[20:23], v[96:99], 0
    ds_read2_b64 v[136:139], v140 offset0:0 offset1:1
    s_nop 5
    v_pk_mul_f32 v[28:29], v[36:37], v[100:101]
    v_pk_mul_f32 v[30:31], v[38:39], v[102:103]
    v_pk_mul_f32 v[32:33], v[40:41], v[100:101]
    v_pk_mul_f32 v[34:35], v[42:43], v[102:103]
    v_pk_fma_f32 v[28:29], v[40:41], v[104:105], v[28:29]
    v_pk_fma_f32 v[30:31], v[42:43], v[106:107], v[30:31]
    v_pk_fma_f32 v[32:33], v[36:37], v[104:105], v[32:33] neg_lo:[1,0,0] neg_hi:[1,0,0]
    v_pk_fma_f32 v[34:35], v[38:39], v[106:107], v[34:35] neg_lo:[1,0,0] neg_hi:[1,0,0]
    v_cvt_pk_bf16_f32 v20, v28, v32
    v_cvt_pk_bf16_f32 v21, v29, v33
    v_cvt_pk_bf16_f32 v22, v30, v34
    v_cvt_pk_bf16_f32 v23, v31, v35
    s_nop 1
    v_mfma_f32_16x16x32_bf16 v[36:39], v[92:95], v[20:23], 0
    v_mfma_f32_16x16x32_bf16 v[40:43], v[96:99], v[20:23], 0
    s_cmp_eq_u32 s4, 0
    s_cbranch_scc1 L_sa_16
L_sa_17:
    s_nop 4
    v_pk_mul_f32 v[28:29], v[36:37], v[120:121]
    v_pk_mul_f32 v[30:31], v[38:39], v[122:123]
    v_pk_mul_f32 v[32:33], v[40:41], v[120:121]
    v_pk_mul_f32 v[34:35], v[42:43], v[122:123]
    v_pk_fma_f32 v[28:29], v[40:41], v[124:125], v[28:29] neg_lo:[1,0,0] neg_hi:[1,0,0]
    v_pk_fma_f32 v[30:31], v[42:43], v[126:127], v[30:31] neg_lo:[1,0,0] neg_hi:[1,0,0]
    v_pk_fma_f32 v[32:33], v[36:37], v[124:125], v[32:33]
    v_pk_fma_f32 v[34:35], v[38:39], v[126:127], v[34:35]
    v_cvt_pk_bf16_f32 v20, v32, v28
    v_cvt_pk_bf16_f32 v21, v33, v29
    v_cvt_pk_bf16_f32 v22, v34, v30
    v_cvt_pk_bf16_f32 v23, v35, v31
    s_nop 1
    v_mfma_f32_16x16x32_bf16 v[36:39], v[20:23], v[96:99], 0
    v_mfma_f32_16x16x32_bf16 v[40:43], v[20:23], v[92:95], 0
    s_nop 6
    v_pk_mul_f32 v[28:29], v[36:37], v[100:101]
    v_pk_mul_f32 v[30:31], v[38:39], v[102:103]
    v_pk_mul_f32 v[32:33], v[40:41], v[100:101]
    v_pk_mul_f32 v[34:35], v[42:43], v[102:103]
    v_pk_fma_f32 v[28:29], v[40:41], v[104:105], v[28:29] neg_lo:[1,0,0] neg_hi:[1,0,0]
    v_pk_fma_f32 v[30:31], v[42:43], v[106:107], v[30:31] neg_lo:[1,0,0] neg_hi:[1,0,0]
    v_pk_fma_f32 v[32:33], v[36:37], v[104:105], v[32:33]
    v_pk_fma_f32 v[34:35], v[38:39], v[106:107], v[34:35]
    v_cvt_pk_bf16_f32 v20, v32, v28
    v_cvt_pk_bf16_f32 v21, v33, v29
    v_cvt_pk_bf16_f32 v22, v34, v30
    v_cvt_pk_bf16_f32 v23, v35, v31
    s_nop 1
    v_mfma_f32_16x16x32_bf16 v[36:39], v[96:99], v[20:23], 0
    v_mfma_f32_16x16x32_bf16 v[40:43], v[92:95], v[20:23], 0
    s_nop 7
    v_cvt_pk_bf16_f32 v28, v36, v40
    v_cvt_pk_bf16_f32 v29, v37, v41
    v_cvt_pk_bf16_f32 v30, v38, v42
    v_cvt_pk_bf16_f32 v31, v39, v43
    ds_write2st64_b32 v163, v28, v29 offset0:0 offset1:5
    ds_write2st64_b32 v163, v30, v31 offset0:10 offset1:15
    s_waitcnt lgkmcnt(0)
    s_branch L_b5
L_poll_10:
    s_sub_u32 s40, s40, 1
    s_cbranch_scc1 L_polld_11
    s_lshr_b64 s[38:39], vcc, 1
    s_or_b64 vcc, vcc, s[38:39]
    s_lshr_b64 s[38:39], vcc, 2
    s_or_b64 exec, vcc, s[38:39]
    global_load_dwordx4 v[20:23], v5, s[34:35] sc1
    global_load_dwordx4 v[24:27], v5, s[36:37] sc1
    s_mov_b64 exec, -1
    s_waitcnt vmcnt(0)
    s_branch L_pollc_12
L_poll_13:
    s_sub_u32 s40, s40, 1
    s_cbranch_scc1 L_polld_14
    global_load_dwordx4 v[20:23], v17, s[32:33] sc1
    global_load_dwordx4 v[24:27], v17, s[32:33] offset:1024 sc1
    s_waitcnt vmcnt(0)
    s_branch L_pollc_15
L_sa_8:
    s_mov_b64 exec, 1
    s_waitcnt lgkmcnt(0)
    v_fmac_f32 v36, 0x45244112, v136
    v_fmac_f32 v40, 0x45244112, v137
    s_nop 0
    v_fmac_f32 v44, 0x45244112, v138
    v_fmac_f32 v48, 0x45244112, v139
    s_mov_b64 exec, -1
    s_branch L_sa_9
L_sa_16:
    s_mov_b64 exec, 1
    s_waitcnt lgkmcnt(0)
    s_nop 2
    v_fmac_f32 v36, 0x45244112, v136
    v_fmac_f32 v40, 0x45244112, v137
    s_mov_b64 exec, -1
    s_branch L_sa_17
L_h0:
    s_mov_b32 s52, 0xffff0000
    v_mov_b32 v20, 0
    v_mov_b32 v21, 0
    v_mov_b32 v22, 0
    v_mov_b32 v23, 0
    v_mov_b32 v28, 28672
    ds_write_b128 v28, v[20:23]
    s_mul_i32 s54, s4, 25
    s_add_u32 s54, s54, s5
    s_cmp_lt_u32 s54, 45
    s_cselect_b32 s42, -5, 35
    s_add_u32 s54, s54, s42
    s_mul_i32 s42, s4, 5
    s_add_u32 s42, s42, s5
    s_add_u32 s42, s42, 40
    s_cmp_lt_u32 s5, 5
    s_cselect_b32 s54, s42, s54
    s_cmp_lt_u32 s5, 30
    s_cselect_b32 s54, s54, 0xf1
    s_sub_u32 s47, s5, 0
    s_mul_i32 s47, s47, 48
    s_movk_i32 s46, 0x2aab
    s_mul_i32 s43, s4, 642
    s_movk_i32 s7, 5136
    v_add_u32 v90, s47, v1
    v_add_u32 v90, 0, v90
    v_min_u32 v90, 1535, v90
    v_mul_u32_u24 v91, s46, v90
    v_lshrrev_b32 v91, 16, v91
    v_mul_u32_u24 v92, 6, v91
    v_sub_u32 v92, v90, v92
    v_lshlrev_b32 v92, 7, v92
    v_min_u32 v92, 638, v92
    v_add_u32 v92, s43, v92
    v_mad_u32_u24 v92, v91, s7, v92
    v_and_b32 v120, -4, v92
    s_waitcnt lgkmcnt(0)
    s_load_dword s55, s[32:33], 73728
    s_barrier
    s_cmp_lt_u32 s5, 5
    s_cbranch_scc0 L_h0_v
    s_barrier
L_h0_v:
    s_mov_b32 exec_hi, 0xffff
    global_load_dword v125, v120, s[12:13]
L_w20_18:
    s_mov_b64 exec, -1
    s_max_u32 s43, s5, 20
    s_mul_i32 s42, s4, 12
    s_add_u32 s42, s42, s43
    s_sub_u32 s42, s42, 20
    s_mul_i32 s43, s42, 20480
    s_lshl_b32 s42, s42, 5
    v_lshrrev_b32 v128, 1, v1
    v_mul_u32_u24 v128, 3072, v128
    v_and_b32 v90, 16, v2
    v_add_u32 v128, v128, v90
    s_add_u32 s56, s20, s42
    s_addc_u32 s57, s21, 0
    s_add_u32 s7, s43, 10240
    s_add_u32 s62, s22, s7
    s_addc_u32 s63, s23, 0
    s_mul_i32 s43, s5, 15
    s_min_u32 s43, s43, 306
    s_add_u32 s7, s43, s4
    s_and_b32 s7, s7, 1
    s_sub_u32 s43, s43, s7
    s_mul_i32 s42, s4, 321
    s_add_u32 s43, s43, s42
    s_lshl_b32 s43, s43, 1
    v_lshrrev_b32 v90, 1, v1
    v_mul_u32_u24 v90, 5136, v90
    v_lshlrev_b32 v91, 1, v1
    v_xor_b32 v91, v2, v91
    v_and_b32 v91, 16, v91
    v_add3_u32 v11, v90, v91, s43
    s_waitcnt lgkmcnt(0)
    s_and_b32 s55, s55, 0x7f7f7f7f
    s_add_u32 s55, s55, 0x01010101
    s_or_b32 s55, s55, 0x80808080
    s_bfe_u32 s68, s55, 0x80000
    s_bfe_u32 s69, s55, 0x80008
    s_bfe_u32 s70, s55, 0x80010
    s_bfe_u32 s71, s55, 0x80018
    v_lshlrev_b32 v28, 5, v1
    v_lshlrev_b32 v34, 3, v1
    v_and_b32 v34, 24, v34
    v_bfe_u32 v34, s55, v34, 8
    v_mov_b32 v33, 0xffffff00
    s_sub_u32 s42, s54, 40
    s_cmp_lt_u32 s42, 40
    s_cselect_b32 s43, 1.0, 0
    s_and_b32 s42, s54, 3
    s_cselect_b32 s43, 0, s43
    v_mov_b32 v35, s43
    s_lshr_b32 s53, s54, 2
    s_lshl_b32 s46, s53, 10
    s_add_u32 s60, s32, s46
    s_addc_u32 s61, s33, 0
    v_mov_b32 v27, s55
    v_lshlrev_b32 v29, 3, v1
    v_add_u32 v29, 66112, v29
    v_add_u32 v30, 61440, v2
    v_add_u32 v31, 65536, v2
    v_add_u32 v32, 69632, v2
    s_barrier
    s_barrier
    s_sub_u32 s7, s5, 5
    s_cmp_lt_u32 s7, 25
    s_cbranch_scc0 L_pl
    ds_read_b128 v[40:43], v28 offset:26624
    ds_read_b128 v[44:47], v28 offset:26640
    v_lshl_add_u32 v36, s54, 8, v3
    s_waitcnt lgkmcnt(0)
    v_pk_add_f32 v[40:41], v[40:41], v[42:43]
    v_pk_add_f32 v[44:45], v[44:45], v[46:47]
    v_add_f32 v40, v35, v40
    v_pk_add_f32 v[40:41], v[40:41], v[44:45]
    v_add_f32 v40, v40, v41
    v_and_or_b32 v40, v40, v33, v34
    global_store_dword v36, v40, s[32:33] sc1
L_pl:
    s_cmp_ge_u32 s5, 22
    s_cbranch_scc1 L_idle0
    s_barrier
    s_sub_u32 s7, s54, 80
    s_cmp_lt_u32 s7, 160
    s_cbranch_scc0 L_nr_19
    s_and_b32 s7, s54, 3
    s_cbranch_scc1 L_nr_19
    global_load_dwordx4 v[40:43], v2, s[60:61] sc1
L_nr_19:
    s_mov_b32 m0, 81472
    s_nop 0
    global_load_lds_dwordx4 v11, s[12:13]
    v_add_u32 v11, 164352, v11
    s_mov_b32 m0, 82496
    s_nop 0
    global_load_lds_dwordx4 v11, s[12:13]
    v_add_u32 v11, 164352, v11
    s_mov_b32 m0, 83520
    s_nop 0
    global_load_lds_dwordx4 v11, s[12:13]
    v_add_u32 v11, 164352, v11
    s_mov_b32 m0, 84544
    s_nop 0
    global_load_lds_dwordx4 v11, s[12:13]
    v_add_u32 v11, 164352, v11
    s_mov_b32 m0, 85568
    s_nop 0
    global_load_lds_dwordx4 v11, s[12:13]
    v_add_u32 v11, 164352, v11
    s_mov_b32 m0, 86592
    s_nop 0
    global_load_lds_dwordx4 v11, s[12:13]
    v_add_u32 v11, 164352, v11
    s_mov_b32 m0, 87616
    s_nop 0
    global_load_lds_dwordx4 v11, s[12:13]
    v_add_u32 v11, 164352, v11
    s_mov_b32 m0, 88640
    s_nop 0
    global_load_lds_dwordx4 v11, s[12:13]
    s_barrier
    s_waitcnt vmcnt(0)
    s_sub_u32 s7, s54, 80
    s_cmp_lt_u32 s7, 160
    s_cbranch_scc0 L_nr_20
    s_and_b32 s7, s54, 3
    s_cbranch_scc1 L_nr_20
    s_mov_b32 s40, 1000000
L_pollc_23:
    v_xor_b32 v40, s68, v40
    v_xor_b32 v41, s69, v41
    v_xor_b32 v42, s70, v42
    v_xor_b32 v43, s71, v43
    v_or3_b32 v44, v40, v41, v42
    v_or_b32 v44, v44, v43
    v_and_b32 v44, 0xff, v44
    v_cmpx_ne_u32 vcc, 0, v44
    s_cbranch_execnz L_poll_21
L_polld_22:
    s_mov_b64 exec, -1
    v_mov_b32 v44, v40
    v_mov_b32 v45, v41
    v_mov_b32 v46, v42
    v_mov_b32 v47, v43
    s_mov_b32 s42, s53
    s_sub_u32 s7, s42, 40
    s_cmp_lt_u32 s7, 10
    s_cselect_b32 s43, 1.0, 0
    s_lshl_b32 s42, s42, 8
    s_add_u32 s42, s42, 56320
    v_permlane32_swap_b32 v40, v44
    v_permlane32_swap_b32 v41, v45
    v_permlane32_swap_b32 v42, v46
    v_permlane32_swap_b32 v43, v47
    v_pk_add_f32 v[40:41], v[40:41], v[44:45]
    v_pk_add_f32 v[42:43], v[42:43], v[46:47]
    v_mov_b32 v44, v40
    v_mov_b32 v45, v41
    v_mov_b32 v46, v42
    v_mov_b32 v47, v43
    v_permlane16_swap_b32 v40, v44
    v_permlane16_swap_b32 v41, v45
    v_permlane16_swap_b32 v42, v46
    v_permlane16_swap_b32 v43, v47
    v_pk_add_f32 v[40:41], v[40:41], v[44:45]
    v_pk_add_f32 v[42:43], v[42:43], v[46:47]
    v_cvt_pk_bf16_f32 v44, v40, v41
    v_cvt_pk_bf16_f32 v45, v42, v43
    v_lshlrev_b32 v40, 16, v44
    v_and_b32 v41, s52, v44
    v_lshlrev_b32 v42, 16, v45
    v_and_b32 v43, s52, v45
    v_add_f32 v40, s43, v40
    v_add_f32 v41, s43, v41
    v_add_f32 v42, s43, v42
    v_add_f32 v43, s43, v43
    v_cvt_pk_bf16_f32 v44, v40, v41
    v_cvt_pk_bf16_f32 v45, v42, v43
    v_mov_b32 v47, s55
    v_add_u32 v48, s42, v2
    s_mov_b64 exec, 0xffff
    global_store_dwordx4 v48, v[44:47], s[32:33] sc1
    s_mov_b64 exec, -1
L_nr_20:
    s_barrier
    s_mul_i32 s42, s6, 4224
    s_add_u32 s7, s42, 524288
    s_add_u32 s34, s32, s7
    s_addc_u32 s35, s33, 0
    s_mov_b64 exec, 0xff
    global_store_dwordx4 v2, v[20:23], s[34:35] sc1
    s_mov_b64 exec, -1
    s_cmp_lt_u32 s5, 20
    s_cbranch_scc1 L_ne_24
    s_mul_i32 s43, s4, 12
    s_add_u32 s43, s43, s5
    s_mul_i32 s43, s43, 2688
    s_add_u32 s7, s43, 77312
    s_add_u32 s34, s32, s7
    s_addc_u32 s35, s33, 0
    global_store_dwordx4 v2, v[20:23], s[34:35] sc1
    global_store_dwordx4 v2, v[20:23], s[34:35] offset:1024 sc1
    s_mov_b32 exec_hi, 0
    global_store_dwordx4 v2, v[20:23], s[34:35] offset:2048 sc1
    s_mov_b64 exec, -1
L_ne_24:
    s_barrier
    s_waitcnt vmcnt(0)
    global_load_dwordx4 v[40:43], v30, s[32:33] offset:0 sc1
    global_load_dwordx4 v[44:47], v30, s[32:33] offset:1024 sc1
    global_load_dwordx4 v[48:51], v30, s[32:33] offset:2048 sc1
    global_load_dwordx4 v[52:55], v30, s[32:33] offset:3072 sc1
    global_load_dwordx4 v[56:59], v31, s[32:33] offset:0 sc1
    global_load_dwordx4 v[60:63], v31, s[32:33] offset:1024 sc1
    global_load_dwordx4 v[64:67], v31, s[32:33] offset:2048 sc1
    global_load_dwordx4 v[68:71], v31, s[32:33] offset:3072 sc1
    global_load_dwordx4 v[72:75], v32, s[32:33] offset:0 sc1
    global_load_dwordx4 v[76:79], v32, s[32:33] offset:1024 sc1
    s_cmp_lt_u32 s5, 20
    s_cbranch_scc1 L_ne_25
    s_mov_b32 m0, 110144
    s_nop 0
    global_load_lds_dwordx4 v128, s[56:57]
    v_add_u32 v128, 98304, v128
    s_mov_b32 m0, 115264
    s_nop 0
    global_load_lds_dwordx4 v128, s[56:57]
    v_add_u32 v128, 98304, v128
    s_mov_b32 m0, 120384
    s_nop 0
    global_load_lds_dwordx4 v128, s[56:57]
    v_add_u32 v128, 98304, v128
    s_mov_b32 m0, 125504
    s_nop 0
    global_load_lds_dwordx4 v128, s[56:57]
    v_add_u32 v128, 98304, v128
    s_mov_b32 m0, 111168
    s_nop 0
    global_load_lds_dwordx4 v128, s[56:57]
    v_add_u32 v128, 98304, v128
    s_mov_b32 m0, 116288
    s_nop 0
    global_load_lds_dwordx4 v128, s[56:57]
    v_add_u32 v128, 98304, v128
    s_mov_b32 m0, 121408
    s_nop 0
    global_load_lds_dwordx4 v128, s[56:57]
    v_add_u32 v128, 98304, v128
    s_mov_b32 m0, 126528
    s_nop 0
    global_load_lds_dwordx4 v128, s[56:57]
    v_add_u32 v128, 98304, v128
    s_mov_b32 m0, 112192
    s_nop 0
    global_load_lds_dwordx4 v128, s[56:57]
    v_add_u32 v128, 98304, v128
    s_mov_b32 m0, 117312
    s_nop 0
    global_load_lds_dwordx4 v128, s[56:57]
    v_add_u32 v128, 98304, v128
L_ne_25:
    s_barrier
    s_cmp_lt_u32 s5, 20
    s_waitcnt vmcnt(10)
    s_cbranch_scc0 L_h0_m
    s_waitcnt vmcnt(0)
L_h0_m:
    s_mov_b32 s40, 1000000
L_pollc_28:
    v_xor_b32 v80, s55, v43
    v_xor_b32 v81, s55, v47
    v_xor_b32 v82, s55, v51
    v_xor_b32 v83, s55, v55
    v_xor_b32 v84, s55, v59
    v_xor_b32 v85, s55, v63
    v_xor_b32 v86, s55, v67
    v_xor_b32 v87, s55, v71
    v_xor_b32 v88, s55, v75
    v_xor_b32 v89, s55, v79
    v_or3_b32 v80, v80, v81, v82
    v_or3_b32 v80, v80, v83, v84
    v_or3_b32 v80, v80, v85, v86
    v_or3_b32 v80, v80, v87, v88
    v_or_b32 v80, v80, v89
    v_cmpx_ne_u32 vcc, 0, v80
    s_cbranch_execnz L_poll_26
L_polld_27:
    s_mov_b64 exec, -1
    ds_write_b64 v29, v[40:41] offset:0
    ds_write_b64 v29, v[44:45] offset:512
    ds_write_b64 v29, v[48:49] offset:1024
    ds_write_b64 v29, v[52:53] offset:1536
    ds_write_b64 v29, v[56:57] offset:2048
    ds_write_b64 v29, v[60:61] offset:2560
    ds_write_b64 v29, v[64:65] offset:3072
    ds_write_b64 v29, v[68:69] offset:3584
    ds_write_b64 v29, v[72:73] offset:4096
    ds_write_b64 v29, v[76:77] offset:4608
    s_waitcnt lgkmcnt(0)
    s_barrier
    s_barrier
    s_cmp_lt_u32 s5, 20
    s_cbranch_scc1 L_ne_29
    s_mov_b32 m0, 122432
    s_nop 0
    global_load_lds_dwordx4 v128, s[56:57]
    v_add_u32 v128, 98304, v128
    s_mov_b32 m0, 127552
    s_nop 0
    global_load_lds_dwordx4 v128, s[56:57]
    v_add_u32 v128, 98304, v128
    s_mov_b32 m0, 113216
    s_nop 0
    global_load_lds_dwordx4 v128, s[56:57]
    v_add_u32 v128, 98304, v128
    s_mov_b32 m0, 118336
    s_nop 0
    global_load_lds_dwordx4 v128, s[56:57]
    v_add_u32 v128, 98304, v128
    s_mov_b32 m0, 123456
    s_nop 0
    global_load_lds_dwordx4 v128, s[56:57]
    v_add_u32 v128, 98304, v128
    s_mov_b32 m0, 128576
    s_nop 0
    global_load_lds_dwordx4 v128, s[56:57]
    v_add_u32 v128, 98304, v128
    s_mov_b32 m0, 114240
    s_nop 0
    global_load_lds_dwordx4 v128, s[56:57]
    v_add_u32 v128, 98304, v128
    s_mov_b32 m0, 119360
    s_nop 0
    global_load_lds_dwordx4 v128, s[56:57]
    v_add_u32 v128, 98304, v128
    s_mov_b32 m0, 124480
    s_nop 0
    global_load_lds_dwordx4 v128, s[56:57]
    v_add_u32 v128, 98304, v128
    s_mov_b32 m0, 129600
    s_nop 0
    global_load_lds_dwordx4 v128, s[56:57]
    s_mov_b32 m0, 140864
    v_add_u32 v90, 0, v2
    global_load_lds_dwordx4 v90, s[62:63] offset:0
    global_load_lds_dwordx4 v90, s[62:63] offset:1024
    global_load_lds_dwordx4 v90, s[62:63] offset:2048
    global_load_lds_dwordx4 v90, s[62:63] offset:3072
    s_mov_b32 m0, 144960
    v_add_u32 v90, 4096, v2
    global_load_lds_dwordx4 v90, s[62:63] offset:0
    global_load_lds_dwordx4 v90, s[62:63] offset:1024
    global_load_lds_dwordx4 v90, s[62:63] offset:2048
    global_load_lds_dwordx4 v90, s[62:63] offset:3072
    s_mov_b32 m0, 149056
    v_add_u32 v90, 8192, v2
    global_load_lds_dwordx4 v90, s[62:63] offset:0
    global_load_lds_dwordx4 v90, s[62:63] offset:1024
L_ne_29:
    s_cmp_lg_u32 s2, 8
    s_cbranch_scc1 L_h0_ne
    v_mov_b32 v26, 73728
    s_mov_b64 exec, 1
    global_store_dword v26, v27, s[32:33] sc1
    s_mov_b64 exec, -1
L_h0_ne:
L_hend0:
    v_mul_u32_u24 v60, 4224, v1
    v_add_u32 v60, 524288, v60
    v_add_u32 v61, 270336, v60
    v_mov_b32 v62, 28676
    v_and_b32 v63, 15, v1
    v_lshlrev_b32 v63, 7, v63
    v_add_u32 v63, 524416, v63
    s_movk_i32 s42, 4224
    s_cmp_lt_u32 s5, 20
    s_barrier
    s_waitcnt vmcnt(0)
    s_cbranch_scc1 L_hx0
    s_barrier
    global_load_dwordx2 v[64:65], v60, s[32:33] sc1
    global_load_dwordx2 v[66:67], v61, s[32:33] sc1
    s_mov_b32 s40, 1000000
    s_waitcnt vmcnt(0)
L_pollc_32:
    v_xor_b32 v68, v65, v67
    v_xor_b32 v69, s55, v65
    v_or_b32 v68, v68, v69
    v_cmpx_ne_u32 vcc, 0, v68
    s_cbranch_execnz L_poll_30
L_polld_31:
    s_mov_b64 exec, -1
    v_max_u32 v64, v64, v66
    s_nop 1
    v_max_u32_dpp v64, v64, v64 row_ror:8 row_mask:0xf bank_mask:0xf
    s_nop 1
    v_max_u32_dpp v64, v64, v64 row_ror:4 row_mask:0xf bank_mask:0xf
    s_nop 1
    v_max_u32_dpp v64, v64, v64 row_ror:2 row_mask:0xf bank_mask:0xf
    s_nop 1
    v_max_u32_dpp v64, v64, v64 row_ror:1 row_mask:0xf bank_mask:0xf
    s_mov_b32 exec_lo, 0x00010001
    s_mov_b32 exec_hi, 0x00010001
    ds_max_u32 v62, v64
    s_mov_b64 exec, -1
    s_waitcnt lgkmcnt(0)
    s_barrier
    s_cmp_ge_u32 s5, 30
    s_cbranch_scc1 L_hx0
    ds_read_b32 v21, v62
    s_mul_i32 s46, s4, 10
    s_add_u32 s46, s46, s5
    s_sub_u32 s46, s46, 20
    v_mov_b32 v26, 0
    v_mov_b32 v27, 0
    s_waitcnt lgkmcnt(0)
    v_readfirstlane_b32 s42, v21
    s_nop 0
    s_and_b32 s43, s42, 255
    s_mul_i32 s43, s43, 4224
    s_add_u32 s7, s43, 526464
    s_add_u32 s34, s32, s7
    s_addc_u32 s35, s33, 0
    v_and_b32 v20, 1, v1
    v_lshrrev_b32 v21, 4, v1
    v_lshl_add_u32 v20, v20, 2, v21
    s_lshl_b32 s7, s46, 3
    v_add_u32 v20, s7, v20
    s_lshr_b32 s53, s46, 4
    s_cmp_ge_u32 s53, 3
    s_cselect_b32 s7, 3, 0
    s_sub_u32 s53, s53, s7
    s_mul_i32 s7, s7, 342
    s_and_b32 s7, s7, 1024
    v_bfe_u32 v26, v20, 1, 6
    v_lshl_add_u32 v26, v26, 4, s7
    global_load_dwordx4 v[32:35], v26, s[34:35] sc1
    s_barrier
    s_barrier
    v_lshlrev_b32 v20, 1, v20
    v_add_u32 v21, 69952, v20
    v_mov_b32 v22, 0
    ds_read_u16_d16_hi v22, v21
    s_and_b32 s43, s42, 0x7ff
    s_mul_i32 s43, s43, 1280
    s_add_u32 s72, s28, s43
    s_addc_u32 s73, s29, 0
    s_and_b32 s43, s42, 0xfffff800
    s_or_b32 s43, s43, 0x400
    s_xor_b32 s47, s43, 0x80000000
    s_not_b32 s7, s43
    s_cmp_lt_i32 s43, 0
    s_cselect_b32 s43, s47, s7
    v_mov_b32 v28, s43
    v_mul_f32 v28, 0xbfb8aa3b, v28
    v_exp_f32 v28, v28
    s_nop 0
    v_add_f32 v28, 1.0, v28
    v_rcp_f32 v28, v28
    v_lshrrev_b32 v29, 1, v1
    v_mul_u32_u24 v29, 2688, v29
    v_and_b32 v30, 16, v2
    v_add_u32 v29, v29, v30
    v_add_u32 v30, 86016, v29
    v_add_u32 v31, 172032, v29
    s_lshl_b32 s46, s46, 5
    s_add_u32 s7, s46, 131072
    s_add_u32 s36, s32, s7
    s_addc_u32 s37, s33, 0
    s_waitcnt lgkmcnt(0)
    v_mul_f32 v22, v22, v28
    s_mov_b32 s40, 1000000
    s_waitcnt vmcnt(0)
L_pollc_35:
    v_cmpx_ne_u32 vcc, s55, v35
    s_cbranch_execnz L_poll_33
L_polld_34:
    s_mov_b64 exec, -1
    s_cmp_eq_u32 s53, 1
    s_cselect_b64 vcc, -1, 0
    v_cndmask_b32 v27, v32, v33, vcc
    s_cmp_eq_u32 s53, 2
    s_cselect_b64 vcc, -1, 0
    v_cndmask_b32 v27, v27, v34, vcc
    v_and_b32 v32, 16, v1
    v_lshrrev_b32 v27, v32, v27
    v_lshlrev_b32 v27, 16, v27
    global_load_dwordx4 v[36:39], v29, s[36:37] sc1
    global_load_dwordx4 v[40:43], v30, s[36:37] sc1
    global_load_dwordx4 v[44:47], v31, s[36:37] sc1
    s_mov_b32 s40, 1000000
    s_waitcnt vmcnt(0)
L_pollc_38:
    v_xor_b32 v36, s68, v36
    v_xor_b32 v37, s69, v37
    v_xor_b32 v38, s70, v38
    v_xor_b32 v39, s71, v39
    v_xor_b32 v40, s68, v40
    v_xor_b32 v41, s69, v41
    v_xor_b32 v42, s70, v42
    v_xor_b32 v43, s71, v43
    v_xor_b32 v44, s68, v44
    v_xor_b32 v45, s69, v45
    v_xor_b32 v46, s70, v46
    v_xor_b32 v47, s71, v47
    v_or3_b32 v48, v36, v37, v38
    v_or3_b32 v49, v39, v40, v41
    v_or3_b32 v48, v48, v42, v43
    v_or3_b32 v49, v49, v44, v45
    v_or3_b32 v48, v48, v46, v47
    v_or_b32 v48, v48, v49
    v_and_b32 v48, 0xff, v48
    v_cmpx_ne_u32 vcc, 0, v48
    s_cbranch_execnz L_poll_36
L_polld_37:
    s_mov_b64 exec, -1
    v_pk_add_f32 v[36:37], v[36:37], v[40:41]
    v_pk_add_f32 v[38:39], v[38:39], v[42:43]
    v_pk_add_f32 v[36:37], v[36:37], v[44:45]
    v_pk_add_f32 v[38:39], v[38:39], v[46:47]
    s_nop 1
    v_permlane32_swap_b32 v36, v38
    v_permlane32_swap_b32 v37, v39
    v_pk_add_f32 v[36:37], v[36:37], v[38:39]
    s_nop 1
    v_permlane16_swap_b32 v36, v37
    v_add_f32 v36, v36, v37
    s_nop 1
    v_add_f32_dpp v36, v36, v36 row_ror:8 row_mask:0xf bank_mask:0xf
    s_nop 1
    v_add_f32_dpp v36, v36, v36 row_ror:4 row_mask:0xf bank_mask:0xf
    s_nop 1
    v_add_f32_dpp v36, v36, v36 row_ror:2 row_mask:0xf bank_mask:0xf
    v_fma_f32 v36, v36, v22, v27
    v_cvt_pk_bf16_f32 v36, v36, v36
    s_mov_b32 exec_lo, 0x00030003
    s_mov_b32 exec_hi, 0x00030003
    global_store_short v20, v36, s[72:73]
    s_mov_b64 exec, -1
L_hx0:
    s_endpgm
L_idle0:
    s_sub_u32 s42, s5, 22
    s_mul_i32 s47, s42, 96
    s_mul_i32 s43, s4, 384
    s_movk_i32 s46, 0x5556
    s_movk_i32 s7, 2688
    s_mul_i32 s42, s4, 245760
    v_add_u32 v90, s47, v1
    v_add_u32 v90, 0, v90
    v_min_u32 v90, 959, v90
    v_add_u32 v90, 0, v90
    v_mul_u32_u24 v91, s46, v90
    v_lshrrev_b32 v91, 16, v91
    v_lshl_add_u32 v90, v90, 7, s43
    v_mad_u32_u24 v130, v91, s7, v90
    v_add_u32 v90, s47, v1
    v_add_u32 v90, 48, v90
    v_min_u32 v90, 959, v90
    v_add_u32 v90, 0, v90
    v_mul_u32_u24 v91, s46, v90
    v_lshrrev_b32 v91, 16, v91
    v_lshl_add_u32 v90, v90, 7, s43
    v_mad_u32_u24 v131, v91, s7, v90
    v_add_u32 v90, s47, v1
    v_add_u32 v90, 0, v90
    v_min_u32 v90, 959, v90
    v_add_u32 v90, 960, v90
    v_mul_u32_u24 v91, s46, v90
    v_lshrrev_b32 v91, 16, v91
    v_lshl_add_u32 v90, v90, 7, s43
    v_mad_u32_u24 v132, v91, s7, v90
    v_add_u32 v90, s47, v1
    v_add_u32 v90, 48, v90
    v_min_u32 v90, 959, v90
    v_add_u32 v90, 960, v90
    v_mul_u32_u24 v91, s46, v90
    v_lshrrev_b32 v91, 16, v91
    v_lshl_add_u32 v90, v90, 7, s43
    v_mad_u32_u24 v133, v91, s7, v90
    v_add_u32 v90, s47, v1
    v_add_u32 v90, 0, v90
    v_min_u32 v90, 959, v90
    v_add_u32 v90, 0, v90
    v_lshl_add_u32 v134, v90, 7, s42
    v_add_u32 v90, s47, v1
    v_add_u32 v90, 48, v90
    v_min_u32 v90, 959, v90
    v_add_u32 v90, 0, v90
    v_lshl_add_u32 v135, v90, 7, s42
    s_barrier
    s_sub_u32 s7, s54, 80
    s_cmp_lt_u32 s7, 160
    s_cbranch_scc0 L_nr_39
    s_and_b32 s7, s54, 3
    s_cbranch_scc1 L_nr_39
    global_load_dwordx4 v[40:43], v2, s[60:61] sc1
L_nr_39:
    s_mov_b32 exec_hi, 0xffff
    global_load_dword v125, v130, s[20:21]
    global_load_dword v125, v131, s[20:21]
    s_mov_b64 exec, -1
    s_barrier
    s_waitcnt vmcnt(2)
    s_sub_u32 s7, s54, 80
    s_cmp_lt_u32 s7, 160
    s_cbranch_scc0 L_nr_40
    s_and_b32 s7, s54, 3
    s_cbranch_scc1 L_nr_40
    s_mov_b32 s40, 1000000
L_pollc_43:
    v_xor_b32 v40, s68, v40
    v_xor_b32 v41, s69, v41
    v_xor_b32 v42, s70, v42
    v_xor_b32 v43, s71, v43
    v_or3_b32 v44, v40, v41, v42
    v_or_b32 v44, v44, v43
    v_and_b32 v44, 0xff, v44
    v_cmpx_ne_u32 vcc, 0, v44
    s_cbranch_execnz L_poll_41
L_polld_42:
    s_mov_b64 exec, -1
    v_mov_b32 v44, v40
    v_mov_b32 v45, v41
    v_mov_b32 v46, v42
    v_mov_b32 v47, v43
    s_mov_b32 s42, s53
    s_sub_u32 s7, s42, 40
    s_cmp_lt_u32 s7, 10
    s_cselect_b32 s43, 1.0, 0
    s_lshl_b32 s42, s42, 8
    s_add_u32 s42, s42, 56320
    v_permlane32_swap_b32 v40, v44
    v_permlane32_swap_b32 v41, v45
    v_permlane32_swap_b32 v42, v46
    v_permlane32_swap_b32 v43, v47
    v_pk_add_f32 v[40:41], v[40:41], v[44:45]
    v_pk_add_f32 v[42:43], v[42:43], v[46:47]
    v_mov_b32 v44, v40
    v_mov_b32 v45, v41
    v_mov_b32 v46, v42
    v_mov_b32 v47, v43
    v_permlane16_swap_b32 v40, v44
    v_permlane16_swap_b32 v41, v45
    v_permlane16_swap_b32 v42, v46
    v_permlane16_swap_b32 v43, v47
    v_pk_add_f32 v[40:41], v[40:41], v[44:45]
    v_pk_add_f32 v[42:43], v[42:43], v[46:47]
    v_cvt_pk_bf16_f32 v44, v40, v41
    v_cvt_pk_bf16_f32 v45, v42, v43
    v_lshlrev_b32 v40, 16, v44
    v_and_b32 v41, s52, v44
    v_lshlrev_b32 v42, 16, v45
    v_and_b32 v43, s52, v45
    v_add_f32 v40, s43, v40
    v_add_f32 v41, s43, v41
    v_add_f32 v42, s43, v42
    v_add_f32 v43, s43, v43
    v_cvt_pk_bf16_f32 v44, v40, v41
    v_cvt_pk_bf16_f32 v45, v42, v43
    v_mov_b32 v47, s55
    v_add_u32 v48, s42, v2
    s_mov_b64 exec, 0xffff
    global_store_dwordx4 v48, v[44:47], s[32:33] sc1
    s_mov_b64 exec, -1
L_nr_40:
    s_barrier
    s_mov_b32 exec_hi, 0xffff
    global_load_dword v125, v132, s[20:21]
    global_load_dword v125, v133, s[20:21]
    global_load_dword v125, v134, s[22:23]
    global_load_dword v125, v135, s[22:23]
    s_mov_b64 exec, -1
    s_waitcnt vmcnt(6)
    s_mul_i32 s42, s6, 4224
    s_add_u32 s7, s42, 524288
    s_add_u32 s34, s32, s7
    s_addc_u32 s35, s33, 0
    s_mov_b64 exec, 0xff
    global_store_dwordx4 v2, v[20:23], s[34:35] sc1
    s_mov_b64 exec, -1
    s_cmp_lt_u32 s5, 20
    s_cbranch_scc1 L_ne_44
    s_mul_i32 s43, s4, 12
    s_add_u32 s43, s43, s5
    s_mul_i32 s43, s43, 2688
    s_add_u32 s7, s43, 77312
    s_add_u32 s34, s32, s7
    s_addc_u32 s35, s33, 0
    global_store_dwordx4 v2, v[20:23], s[34:35] sc1
    global_store_dwordx4 v2, v[20:23], s[34:35] offset:1024 sc1
    s_mov_b32 exec_hi, 0
    global_store_dwordx4 v2, v[20:23], s[34:35] offset:2048 sc1
    s_mov_b64 exec, -1
L_ne_44:
    s_waitcnt vmcnt(6)
    s_mov_b32 m0, 110144
    s_nop 0
    global_load_lds_dwordx4 v128, s[56:57]
    v_add_u32 v128, 98304, v128
    s_mov_b32 m0, 115264
    s_nop 0
    global_load_lds_dwordx4 v128, s[56:57]
    v_add_u32 v128, 98304, v128
    s_mov_b32 m0, 120384
    s_nop 0
    global_load_lds_dwordx4 v128, s[56:57]
    v_add_u32 v128, 98304, v128
    s_mov_b32 m0, 125504
    s_nop 0
    global_load_lds_dwordx4 v128, s[56:57]
    v_add_u32 v128, 98304, v128
    s_mov_b32 m0, 111168
    s_nop 0
    global_load_lds_dwordx4 v128, s[56:57]
    v_add_u32 v128, 98304, v128
    s_mov_b32 m0, 116288
    s_nop 0
    global_load_lds_dwordx4 v128, s[56:57]
    v_add_u32 v128, 98304, v128
    s_mov_b32 m0, 121408
    s_nop 0
    global_load_lds_dwordx4 v128, s[56:57]
    v_add_u32 v128, 98304, v128
    s_mov_b32 m0, 126528
    s_nop 0
    global_load_lds_dwordx4 v128, s[56:57]
    v_add_u32 v128, 98304, v128
    s_mov_b32 m0, 112192
    s_nop 0
    global_load_lds_dwordx4 v128, s[56:57]
    v_add_u32 v128, 98304, v128
    s_mov_b32 m0, 117312
    s_nop 0
    global_load_lds_dwordx4 v128, s[56:57]
    v_add_u32 v128, 98304, v128
    global_load_dwordx4 v[40:43], v30, s[32:33] offset:0 sc1
    global_load_dwordx4 v[44:47], v30, s[32:33] offset:1024 sc1
    global_load_dwordx4 v[48:51], v30, s[32:33] offset:2048 sc1
    global_load_dwordx4 v[52:55], v30, s[32:33] offset:3072 sc1
    global_load_dwordx4 v[56:59], v31, s[32:33] offset:0 sc1
    global_load_dwordx4 v[60:63], v31, s[32:33] offset:1024 sc1
    global_load_dwordx4 v[64:67], v31, s[32:33] offset:2048 sc1
    global_load_dwordx4 v[68:71], v31, s[32:33] offset:3072 sc1
    global_load_dwordx4 v[72:75], v32, s[32:33] offset:0 sc1
    global_load_dwordx4 v[76:79], v32, s[32:33] offset:1024 sc1
    s_mov_b32 m0, 122432
    s_nop 0
    global_load_lds_dwordx4 v128, s[56:57]
    v_add_u32 v128, 98304, v128
    s_mov_b32 m0, 127552
    s_nop 0
    global_load_lds_dwordx4 v128, s[56:57]
    v_add_u32 v128, 98304, v128
    s_mov_b32 m0, 113216
    s_nop 0
    global_load_lds_dwordx4 v128, s[56:57]
    v_add_u32 v128, 98304, v128
    s_mov_b32 m0, 118336
    s_nop 0
    global_load_lds_dwordx4 v128, s[56:57]
    v_add_u32 v128, 98304, v128
    s_mov_b32 m0, 123456
    s_nop 0
    global_load_lds_dwordx4 v128, s[56:57]
    v_add_u32 v128, 98304, v128
    s_mov_b32 m0, 128576
    s_nop 0
    global_load_lds_dwordx4 v128, s[56:57]
    v_add_u32 v128, 98304, v128
    s_waitcnt vmcnt(6)
    s_mov_b32 s40, 1000000
L_pollc_47:
    v_xor_b32 v80, s55, v43
    v_xor_b32 v81, s55, v47
    v_xor_b32 v82, s55, v51
    v_xor_b32 v83, s55, v55
    v_xor_b32 v84, s55, v59
    v_xor_b32 v85, s55, v63
    v_xor_b32 v86, s55, v67
    v_xor_b32 v87, s55, v71
    v_xor_b32 v88, s55, v75
    v_xor_b32 v89, s55, v79
    v_or3_b32 v80, v80, v81, v82
    v_or3_b32 v80, v80, v83, v84
    v_or3_b32 v80, v80, v85, v86
    v_or3_b32 v80, v80, v87, v88
    v_or_b32 v80, v80, v89
    v_cmpx_ne_u32 vcc, 0, v80
    s_cbranch_execnz L_poll_45
L_polld_46:
    s_mov_b64 exec, -1
    ds_write_b64 v29, v[40:41] offset:0
    ds_write_b64 v29, v[44:45] offset:512
    ds_write_b64 v29, v[48:49] offset:1024
    ds_write_b64 v29, v[52:53] offset:1536
    ds_write_b64 v29, v[56:57] offset:2048
    ds_write_b64 v29, v[60:61] offset:2560
    ds_write_b64 v29, v[64:65] offset:3072
    ds_write_b64 v29, v[68:69] offset:3584
    ds_write_b64 v29, v[72:73] offset:4096
    ds_write_b64 v29, v[76:77] offset:4608
    s_waitcnt lgkmcnt(0)
    s_barrier
    s_waitcnt vmcnt(0)
    s_barrier
    s_barrier
    s_mov_b32 m0, 114240
    s_nop 0
    global_load_lds_dwordx4 v128, s[56:57]
    v_add_u32 v128, 98304, v128
    s_mov_b32 m0, 119360
    s_nop 0
    global_load_lds_dwordx4 v128, s[56:57]
    v_add_u32 v128, 98304, v128
    s_mov_b32 m0, 124480
    s_nop 0
    global_load_lds_dwordx4 v128, s[56:57]
    v_add_u32 v128, 98304, v128
    s_mov_b32 m0, 129600
    s_nop 0
    global_load_lds_dwordx4 v128, s[56:57]
    s_mov_b32 m0, 140864
    v_add_u32 v90, 0, v2
    global_load_lds_dwordx4 v90, s[62:63] offset:0
    global_load_lds_dwordx4 v90, s[62:63] offset:1024
    global_load_lds_dwordx4 v90, s[62:63] offset:2048
    global_load_lds_dwordx4 v90, s[62:63] offset:3072
    s_mov_b32 m0, 144960
    v_add_u32 v90, 4096, v2
    global_load_lds_dwordx4 v90, s[62:63] offset:0
    global_load_lds_dwordx4 v90, s[62:63] offset:1024
    global_load_lds_dwordx4 v90, s[62:63] offset:2048
    global_load_lds_dwordx4 v90, s[62:63] offset:3072
    s_mov_b32 m0, 149056
    v_add_u32 v90, 8192, v2
    global_load_lds_dwordx4 v90, s[62:63] offset:0
    global_load_lds_dwordx4 v90, s[62:63] offset:1024
    s_branch L_hend0
L_poll_21:
    s_sub_u32 s40, s40, 1
    s_cbranch_scc1 L_polld_22
    global_load_dwordx4 v[40:43], v2, s[60:61] sc1
    s_waitcnt vmcnt(0)
    s_branch L_pollc_23
L_poll_26:
    s_sub_u32 s40, s40, 1
    s_cbranch_scc1 L_polld_27
    global_load_dwordx4 v[40:43], v30, s[32:33] offset:0 sc1
    global_load_dwordx4 v[44:47], v30, s[32:33] offset:1024 sc1
    global_load_dwordx4 v[48:51], v30, s[32:33] offset:2048 sc1
    global_load_dwordx4 v[52:55], v30, s[32:33] offset:3072 sc1
    global_load_dwordx4 v[56:59], v31, s[32:33] offset:0 sc1
    global_load_dwordx4 v[60:63], v31, s[32:33] offset:1024 sc1
    global_load_dwordx4 v[64:67], v31, s[32:33] offset:2048 sc1
    global_load_dwordx4 v[68:71], v31, s[32:33] offset:3072 sc1
    global_load_dwordx4 v[72:75], v32, s[32:33] offset:0 sc1
    global_load_dwordx4 v[76:79], v32, s[32:33] offset:1024 sc1
    s_waitcnt vmcnt(0)
    s_branch L_pollc_28
L_poll_30:
    s_sub_u32 s40, s40, 1
    s_cbranch_scc1 L_polld_31
    global_load_dwordx2 v[64:65], v60, s[32:33] sc1
    global_load_dwordx2 v[66:67], v61, s[32:33] sc1
    s_waitcnt vmcnt(0)
    s_branch L_pollc_32
L_poll_33:
    s_sub_u32 s40, s40, 1
    s_cbranch_scc1 L_polld_34
    global_load_dwordx4 v[32:35], v26, s[34:35] sc1
    s_waitcnt vmcnt(0)
    s_branch L_pollc_35
L_poll_36:
    s_sub_u32 s40, s40, 1
    s_cbranch_scc1 L_polld_37
    global_load_dwordx4 v[36:39], v29, s[36:37] sc1
    global_load_dwordx4 v[40:43], v30, s[36:37] sc1
    global_load_dwordx4 v[44:47], v31, s[36:37] sc1
    s_waitcnt vmcnt(0)
    s_branch L_pollc_38
L_poll_41:
    s_sub_u32 s40, s40, 1
    s_cbranch_scc1 L_polld_42
    global_load_dwordx4 v[40:43], v2, s[60:61] sc1
    s_waitcnt vmcnt(0)
    s_branch L_pollc_43
L_poll_45:
    s_sub_u32 s40, s40, 1
    s_cbranch_scc1 L_polld_46
    global_load_dwordx4 v[40:43], v30, s[32:33] offset:0 sc1
    global_load_dwordx4 v[44:47], v30, s[32:33] offset:1024 sc1
    global_load_dwordx4 v[48:51], v30, s[32:33] offset:2048 sc1
    global_load_dwordx4 v[52:55], v30, s[32:33] offset:3072 sc1
    global_load_dwordx4 v[56:59], v31, s[32:33] offset:0 sc1
    global_load_dwordx4 v[60:63], v31, s[32:33] offset:1024 sc1
    global_load_dwordx4 v[64:67], v31, s[32:33] offset:2048 sc1
    global_load_dwordx4 v[68:71], v31, s[32:33] offset:3072 sc1
    global_load_dwordx4 v[72:75], v32, s[32:33] offset:0 sc1
    global_load_dwordx4 v[76:79], v32, s[32:33] offset:1024 sc1
    s_waitcnt vmcnt(0)
    s_branch L_pollc_47
L_h1:
    s_getpc_b64 s[34:35]
L_pc:
    s_add_u32 s36, s34, L_tables-L_pc
    s_addc_u32 s37, s35, 0
    s_sub_u32 s47, s5, 0
    s_mul_i32 s47, s47, 48
    s_movk_i32 s46, 0x2aab
    s_mul_i32 s43, s4, 642
    s_movk_i32 s7, 5136
    v_add_u32 v90, s47, v1
    v_add_u32 v90, 0, v90
    v_min_u32 v90, 1535, v90
    v_mul_u32_u24 v91, s46, v90
    v_lshrrev_b32 v91, 16, v91
    v_mul_u32_u24 v92, 6, v91
    v_sub_u32 v92, v90, v92
    v_lshlrev_b32 v92, 7, v92
    v_min_u32 v92, 638, v92
    v_add_u32 v92, s43, v92
    v_mad_u32_u24 v92, v91, s7, v92
    v_and_b32 v120, -4, v92
    s_waitcnt lgkmcnt(0)
    s_load_dword s55, s[32:33], 73728
    s_mov_b32 m0, 0
    v_add_u32 v20, 0, v2
    global_load_lds_dwordx4 v20, s[36:37] offset:0
    global_load_lds_dwordx4 v20, s[36:37] offset:1024
    global_load_lds_dwordx4 v20, s[36:37] offset:2048
    global_load_lds_dwordx4 v20, s[36:37] offset:3072
    s_mov_b32 m0, 4096
    v_add_u32 v20, 4096, v2
    global_load_lds_dwordx4 v20, s[36:37] offset:0
    global_load_lds_dwordx4 v20, s[36:37] offset:1024
    global_load_lds_dwordx4 v20, s[36:37] offset:2048
    global_load_lds_dwordx4 v20, s[36:37] offset:3072
    s_mov_b32 m0, 8192
    v_add_u32 v20, 8192, v2
    global_load_lds_dwordx4 v20, s[36:37] offset:0
    global_load_lds_dwordx4 v20, s[36:37] offset:1024
    global_load_lds_dwordx4 v20, s[36:37] offset:2048
    s_mul_i32 s54, s4, 25
    s_add_u32 s54, s54, s5
    s_cmp_lt_u32 s54, 45
    s_cselect_b32 s42, -5, 35
    s_add_u32 s54, s54, s42
    s_mul_i32 s42, s4, 5
    s_add_u32 s42, s42, s5
    s_add_u32 s42, s42, 40
    s_cmp_lt_u32 s5, 5
    s_cselect_b32 s54, s42, s54
    s_cmp_lt_u32 s5, 30
    s_cselect_b32 s54, s54, 0xf1
    s_barrier
    s_cmp_lt_u32 s5, 5
    s_cbranch_scc0 L_h1_v
    s_barrier
L_h1_v:
    s_mov_b32 m0, 8192
    v_add_u32 v20, 8192, v2
    global_load_lds_dwordx4 v20, s[36:37] offset:3072
    s_mov_b32 m0, 12288
    v_add_u32 v20, 12288, v2
    global_load_lds_dwordx4 v20, s[36:37] offset:0
    global_load_lds_dwordx4 v20, s[36:37] offset:1024
    global_load_lds_dwordx4 v20, s[36:37] offset:2048
    global_load_lds_dwordx4 v20, s[36:37] offset:3072
    s_mov_b32 m0, 16384
    v_add_u32 v20, 16384, v2
    global_load_lds_dwordx4 v20, s[36:37] offset:0
    global_load_lds_dwordx4 v20, s[36:37] offset:1024
    global_load_lds_dwordx4 v20, s[36:37] offset:2048
    global_load_lds_dwordx4 v20, s[36:37] offset:3072
    s_mov_b32 m0, 20480
    v_add_u32 v20, 20480, v2
    global_load_lds_dwordx4 v20, s[36:37] offset:0
    global_load_lds_dwordx4 v20, s[36:37] offset:1024
    global_load_lds_dwordx4 v20, s[36:37] offset:2048
    global_load_lds_dwordx4 v20, s[36:37] offset:3072
    s_mov_b32 m0, 24576
    v_add_u32 v20, 24576, v2
    global_load_lds_dwordx4 v20, s[36:37] offset:0
    global_load_lds_dwordx4 v20, s[36:37] offset:1024
    s_mov_b32 m0, 71232
    s_nop 0
    global_load_lds_dwordx4 v2, s[16:17]
    s_mov_b64 exec, 0xffff
    global_load_lds_dwordx4 v2, s[16:17] offset:1024
    s_mov_b64 exec, -1
    v_add_u32 v110, s5, v1
    v_and_b32 v110, 7, v110
    v_lshlrev_b32 v114, 5, v110
    v_mul_u32_u24 v110, 22, v110
    v_mul_u32_u24 v110, 16640, v110
    s_lshl_b32 s42, s6, 6
    s_add_u32 s42, s42, 8588348
    v_add_u32 v110, s42, v110
    v_and_b32 v111, 7, v1
    v_lshl_add_u32 v114, v111, 2, v114
    v_mul_u32_u24 v114, 11392, v114
    s_min_u32 s7, s5, 21
    s_mul_i32 s42, s4, 22
    s_add_u32 s42, s42, s7
    s_lshl_b32 s42, s42, 6
    s_add_u32 s42, s42, 4205756
    v_add_u32 v114, s42, v114
    s_mov_b32 exec_hi, 0xffff
    global_load_dword v125, v120, s[10:11]
L_w20_48:
    s_mov_b64 exec, -1
    s_max_u32 s43, s5, 20
    s_mul_i32 s42, s4, 12
    s_add_u32 s42, s42, s43
    s_sub_u32 s42, s42, 20
    s_mul_i32 s43, s42, 20480
    s_lshl_b32 s42, s42, 5
    v_lshrrev_b32 v128, 1, v1
    v_mul_u32_u24 v128, 3072, v128
    v_and_b32 v90, 16, v2
    v_add_u32 v128, v128, v90
    s_add_u32 s56, s18, s42
    s_addc_u32 s57, s19, 0
    s_add_u32 s62, s22, s43
    s_addc_u32 s63, s23, 0
    s_mul_i32 s43, s5, 15
    s_min_u32 s43, s43, 306
    s_add_u32 s7, s43, s4
    s_and_b32 s7, s7, 1
    s_sub_u32 s43, s43, s7
    s_mul_i32 s42, s4, 321
    s_add_u32 s43, s43, s42
    s_lshl_b32 s43, s43, 1
    v_lshrrev_b32 v90, 1, v1
    v_mul_u32_u24 v90, 5136, v90
    v_lshlrev_b32 v91, 1, v1
    v_xor_b32 v91, v2, v91
    v_and_b32 v91, 16, v91
    v_add3_u32 v11, v90, v91, s43
    s_waitcnt lgkmcnt(0)
    s_and_b32 s55, s55, 0x7f7f7f7f
    s_add_u32 s55, s55, 0x01010101
    s_or_b32 s55, s55, 0x80808080
    s_waitcnt vmcnt(18)
    s_barrier
    s_barrier
    s_cmp_ge_u32 s5, 22
    s_cbranch_scc1 L_idle1
    v_lshrrev_b32 v4, 5, v1
    v_lshlrev_b32 v4, 10, v4
    v_and_b32 v5, 31, v1
    v_lshl_add_u32 v4, v5, 3, v4
    v_add_u32 v5, 4096, v4
    v_add_u32 v6, 8192, v4
    s_cmp_lg_u32 s4, 0
    s_cbranch_scc1 L_sas_49
    ds_read_b128 v[108:111], v2 offset:0
    ds_read_b128 v[112:115], v2 offset:1024
    ds_read_b128 v[92:95], v2 offset:2048
    ds_read_b128 v[96:99], v2 offset:3072
    ds_read_b128 v[100:103], v2 offset:4096
    ds_read_b128 v[104:107], v2 offset:5120
    ds_read_b128 v[60:63], v2 offset:6144
    ds_read_b128 v[64:67], v2 offset:7168
    ds_read_b128 v[76:79], v2 offset:8192
    ds_read_b128 v[80:83], v2 offset:9216
    ds_read_b128 v[116:119], v2 offset:10240
    v_and_b32 v8, 16, v2
    v_lshrrev_b32 v8, v8, s55
    v_bfe_u32 v9, v8, 8, 8
    v_and_b32 v8, 0xff, v8
    s_waitcnt lgkmcnt(0)
    v_alignbit_b32 v68, v60, v60, 16
    v_xor_b32 v68, v117, v68
    v_alignbit_b32 v69, v61, v61, 16
    v_xor_b32 v69, v117, v69
    v_alignbit_b32 v70, v62, v62, 16
    v_xor_b32 v70, v117, v70
    v_alignbit_b32 v71, v63, v63, 16
    v_xor_b32 v71, v117, v71
    v_alignbit_b32 v72, v64, v64, 16
    v_xor_b32 v72, v117, v72
    v_alignbit_b32 v73, v65, v65, 16
    v_xor_b32 v73, v117, v73
    v_alignbit_b32 v74, v66, v66, 16
    v_xor_b32 v74, v117, v74
    v_alignbit_b32 v75, v67, v67, 16
    v_xor_b32 v75, v117, v75
    v_alignbit_b32 v84, v76, v76, 16
    v_xor_b32 v84, v117, v84
    v_alignbit_b32 v85, v77, v77, 16
    v_xor_b32 v85, v117, v85
    v_alignbit_b32 v86, v78, v78, 16
    v_xor_b32 v86, v117, v86
    v_alignbit_b32 v87, v79, v79, 16
    v_xor_b32 v87, v117, v87
    v_alignbit_b32 v88, v80, v80, 16
    v_xor_b32 v88, v117, v88
    v_alignbit_b32 v89, v81, v81, 16
    v_xor_b32 v89, v117, v89
    v_alignbit_b32 v90, v82, v82, 16
    v_xor_b32 v90, v117, v90
    v_alignbit_b32 v91, v83, v83, 16
    v_xor_b32 v91, v117, v91
    v_add_u32 v116, 151104, v116
    v_add_u32 v117, 160, v116
L_sas_49:
    s_barrier
    s_mov_b32 m0, 73280
    s_nop 0
    global_load_lds_dwordx4 v11, s[10:11]
    v_add_u32 v11, 164352, v11
    s_mov_b32 m0, 74304
    s_nop 0
    global_load_lds_dwordx4 v11, s[10:11]
    v_add_u32 v11, 164352, v11
    s_mov_b32 m0, 75328
    s_nop 0
    global_load_lds_dwordx4 v11, s[10:11]
    v_add_u32 v11, 164352, v11
    s_mov_b32 m0, 76352
    s_nop 0
    global_load_lds_dwordx4 v11, s[10:11]
    v_add_u32 v11, 164352, v11
    s_mov_b32 m0, 77376
    s_nop 0
    global_load_lds_dwordx4 v11, s[10:11]
    v_add_u32 v11, 164352, v11
    s_mov_b32 m0, 78400
    s_nop 0
    global_load_lds_dwordx4 v11, s[10:11]
    v_add_u32 v11, 164352, v11
    s_mov_b32 m0, 79424
    s_nop 0
    global_load_lds_dwordx4 v11, s[10:11]
    v_add_u32 v11, 164352, v11
    s_mov_b32 m0, 80448
    s_nop 0
    global_load_lds_dwordx4 v11, s[10:11]
    s_barrier
    s_waitcnt vmcnt(0)
    s_barrier
    s_cmp_lg_u32 s4, 0
    s_cbranch_scc1 L_sas_52
    global_load_dwordx2 v[12:13], v4, s[32:33] offset:0 sc1
    global_load_dwordx2 v[14:15], v4, s[32:33] offset:2048 sc1
    global_load_dwordx2 v[16:17], v5, s[32:33] offset:0 sc1
    global_load_dwordx2 v[18:19], v5, s[32:33] offset:2048 sc1
    global_load_dwordx2 v[20:21], v6, s[32:33] offset:0 sc1
    global_load_dwordx2 v[22:23], v4, s[32:33] offset:256 sc1
    global_load_dwordx2 v[24:25], v4, s[32:33] offset:2304 sc1
    global_load_dwordx2 v[26:27], v5, s[32:33] offset:256 sc1
    global_load_dwordx2 v[28:29], v5, s[32:33] offset:2304 sc1
    global_load_dwordx2 v[30:31], v6, s[32:33] offset:256 sc1
    global_load_dwordx2 v[32:33], v4, s[32:33] offset:512 sc1
    global_load_dwordx2 v[34:35], v4, s[32:33] offset:2560 sc1
    global_load_dwordx2 v[36:37], v5, s[32:33] offset:512 sc1
    global_load_dwordx2 v[38:39], v5, s[32:33] offset:2560 sc1
    global_load_dwordx2 v[40:41], v6, s[32:33] offset:512 sc1
    global_load_dwordx2 v[42:43], v4, s[32:33] offset:768 sc1
    global_load_dwordx2 v[44:45], v4, s[32:33] offset:2816 sc1
    global_load_dwordx2 v[46:47], v5, s[32:33] offset:768 sc1
    global_load_dwordx2 v[48:49], v5, s[32:33] offset:2816 sc1
    global_load_dwordx2 v[50:51], v6, s[32:33] offset:768 sc1
L_sas_52:
    s_cmp_lg_u32 s4, 0
    s_cbranch_scc1 L_sas_55
    s_mov_b32 s40, 1000000
L_sac_57:
    s_waitcnt vmcnt(0)
    v_xor_b32 v12, v8, v12
    v_xor_b32 v13, v9, v13
    v_xor_b32 v14, v8, v14
    v_xor_b32 v15, v9, v15
    v_xor_b32 v16, v8, v16
    v_xor_b32 v17, v9, v17
    v_xor_b32 v18, v8, v18
    v_xor_b32 v19, v9, v19
    v_xor_b32 v20, v8, v20
    v_xor_b32 v21, v9, v21
    v_xor_b32 v22, v8, v22
    v_xor_b32 v23, v9, v23
    v_xor_b32 v24, v8, v24
    v_xor_b32 v25, v9, v25
    v_xor_b32 v26, v8, v26
    v_xor_b32 v27, v9, v27
    v_xor_b32 v28, v8, v28
    v_xor_b32 v29, v9, v29
    v_xor_b32 v30, v8, v30
    v_xor_b32 v31, v9, v31
    v_xor_b32 v32, v8, v32
    v_xor_b32 v33, v9, v33
    v_xor_b32 v34, v8, v34
    v_xor_b32 v35, v9, v35
    v_xor_b32 v36, v8, v36
    v_xor_b32 v37, v9, v37
    v_xor_b32 v38, v8, v38
    v_xor_b32 v39, v9, v39
    v_xor_b32 v40, v8, v40
    v_xor_b32 v41, v9, v41
    v_xor_b32 v42, v8, v42
    v_xor_b32 v43, v9, v43
    v_xor_b32 v44, v8, v44
    v_xor_b32 v45, v9, v45
    v_xor_b32 v46, v8, v46
    v_xor_b32 v47, v9, v47
    v_xor_b32 v48, v8, v48
    v_xor_b32 v49, v9, v49
    v_xor_b32 v50, v8, v50
    v_xor_b32 v51, v9, v51
    v_or_b32 v10, v12, v13
    v_or3_b32 v10, v10, v14, v15
    v_or3_b32 v10, v10, v16, v17
    v_or3_b32 v10, v10, v18, v19
    v_or3_b32 v10, v10, v20, v21
    v_or3_b32 v10, v10, v22, v23
    v_or3_b32 v10, v10, v24, v25
    v_or3_b32 v10, v10, v26, v27
    v_or3_b32 v10, v10, v28, v29
    v_or3_b32 v10, v10, v30, v31
    v_or3_b32 v10, v10, v32, v33
    v_or3_b32 v10, v10, v34, v35
    v_or3_b32 v10, v10, v36, v37
    v_or3_b32 v10, v10, v38, v39
    v_or3_b32 v10, v10, v40, v41
    v_or3_b32 v10, v10, v42, v43
    v_or3_b32 v10, v10, v44, v45
    v_or3_b32 v10, v10, v46, v47
    v_or3_b32 v10, v10, v48, v49
    v_or3_b32 v10, v10, v50, v51
    v_and_b32 v10, 0xff, v10
    v_cmp_ne_u32 vcc, 0, v10
    s_nop 0
    s_and_b64 vcc, exec, vcc
    s_cbranch_scc1 L_sar_56
L_sar_56_d:
    v_pk_add_f32 v[140:141], v[12:13], v[22:23]
    v_pk_add_f32 v[32:33], v[32:33], v[42:43]
    v_pk_add_f32 v[142:143], v[14:15], v[24:25]
    v_pk_add_f32 v[34:35], v[34:35], v[44:45]
    v_pk_add_f32 v[144:145], v[16:17], v[26:27]
    v_pk_add_f32 v[36:37], v[36:37], v[46:47]
    v_pk_add_f32 v[146:147], v[18:19], v[28:29]
    v_pk_add_f32 v[38:39], v[38:39], v[48:49]
    v_pk_add_f32 v[148:149], v[20:21], v[30:31]
    v_pk_add_f32 v[40:41], v[40:41], v[50:51]
    v_pk_add_f32 v[140:141], v[140:141], v[32:33]
    v_pk_add_f32 v[142:143], v[142:143], v[34:35]
    v_pk_add_f32 v[144:145], v[144:145], v[36:37]
    v_pk_add_f32 v[146:147], v[146:147], v[38:39]
    v_pk_add_f32 v[148:149], v[148:149], v[40:41]
    v_cvt_pk_bf16_f32 v20, v140, v142
    v_cvt_pk_bf16_f32 v21, v144, v146
    v_cvt_pk_bf16_f32 v22, v148, 0
    v_mov_b32 v23, 0
    v_cvt_pk_bf16_f32 v24, v141, v143
    v_cvt_pk_bf16_f32 v25, v145, v147
    v_cvt_pk_bf16_f32 v26, v149, 0
    v_mov_b32 v27, 0
    v_mfma_f32_16x16x32_bf16 v[36:39], v[20:23], v[108:111], 0
    v_mfma_f32_16x16x32_bf16 v[40:43], v[20:23], v[112:115], 0
    v_mfma_f32_16x16x32_bf16 v[44:47], v[24:27], v[108:111], 0
    v_mfma_f32_16x16x32_bf16 v[48:51], v[24:27], v[112:115], 0
    s_nop 4
    v_pk_mul_f32 v[28:29], v[36:37], v[92:93]
    v_pk_mul_f32 v[30:31], v[38:39], v[94:95]
    v_pk_mul_f32 v[32:33], v[40:41], v[92:93]
    v_pk_mul_f32 v[34:35], v[42:43], v[94:95]
    v_pk_fma_f32 v[28:29], v[40:41], v[96:97], v[28:29]
    v_pk_fma_f32 v[30:31], v[42:43], v[98:99], v[30:31]
    v_pk_fma_f32 v[32:33], v[36:37], v[96:97], v[32:33] neg_lo:[1,0,0] neg_hi:[1,0,0]
    v_pk_fma_f32 v[34:35], v[38:39], v[98:99], v[34:35] neg_lo:[1,0,0] neg_hi:[1,0,0]
    v_cvt_pk_bf16_f32 v20, v28, v32
    v_cvt_pk_bf16_f32 v21, v29, v33
    v_cvt_pk_bf16_f32 v22, v30, v34
    v_cvt_pk_bf16_f32 v23, v31, v35
    v_pk_mul_f32 v[52:53], v[44:45], v[100:101]
    v_pk_mul_f32 v[54:55], v[46:47], v[102:103]
    v_pk_mul_f32 v[56:57], v[48:49], v[100:101]
    v_pk_mul_f32 v[58:59], v[50:51], v[102:103]
    v_pk_fma_f32 v[52:53], v[48:49], v[104:105], v[52:53]
    v_pk_fma_f32 v[54:55], v[50:51], v[106:107], v[54:55]
    v_pk_fma_f32 v[56:57], v[44:45], v[104:105], v[56:57] neg_lo:[1,0,0] neg_hi:[1,0,0]
    v_pk_fma_f32 v[58:59], v[46:47], v[106:107], v[58:59] neg_lo:[1,0,0] neg_hi:[1,0,0]
    v_cvt_pk_bf16_f32 v24, v52, v56
    v_cvt_pk_bf16_f32 v25, v53, v57
    v_cvt_pk_bf16_f32 v26, v54, v58
    v_cvt_pk_bf16_f32 v27, v55, v59
    v_mfma_f32_16x16x32_bf16 v[36:39], v[60:63], v[20:23], 0
    v_mfma_f32_16x16x32_bf16 v[40:43], v[68:71], v[20:23], 0
    v_mfma_f32_16x16x32_bf16 v[36:39], v[64:67], v[24:27], v[36:39]
    v_mfma_f32_16x16x32_bf16 v[40:43], v[72:75], v[24:27], v[40:43]
    v_mfma_f32_16x16x32_bf16 v[44:47], v[76:79], v[20:23], 0
    v_mfma_f32_16x16x32_bf16 v[48:51], v[84:87], v[20:23], 0
    v_mfma_f32_16x16x32_bf16 v[44:47], v[80:83], v[24:27], v[44:47]
    v_mfma_f32_16x16x32_bf16 v[48:51], v[88:91], v[24:27], v[48:51]
    s_mov_b32 exec_lo, 0x37773777
    s_mov_b32 exec_hi, 0x37773777
    s_nop 1
    ds_write2_b32 v116, v36, v40 offset0:0 offset1:1
    ds_write2_b32 v116, v37, v41 offset0:80 offset1:81
    ds_write2_b32 v116, v38, v42 offset0:160 offset1:161
    ds_write2_b32 v116, v39, v43 offset0:240 offset1:241
    ds_write2_b32 v117, v44, v48 offset0:0 offset1:1
    ds_write2_b32 v117, v45, v49 offset0:80 offset1:81
    ds_write2_b32 v117, v46, v50 offset0:160 offset1:161
    ds_write2_b32 v117, v47, v51 offset0:240 offset1:241
    s_mov_b64 exec, -1
    s_waitcnt lgkmcnt(0)
L_sas_55:
    s_barrier
    s_waitcnt vmcnt(0)
    s_cmp_lt_u32 s5, 20
    s_cbranch_scc1 L_ne_58
    s_mov_b32 m0, 89664
    s_nop 0
    global_load_lds_dwordx4 v128, s[56:57]
    v_add_u32 v128, 98304, v128
    s_mov_b32 m0, 94784
    s_nop 0
    global_load_lds_dwordx4 v128, s[56:57]
    v_add_u32 v128, 98304, v128
    s_mov_b32 m0, 99904
    s_nop 0
    global_load_lds_dwordx4 v128, s[56:57]
    v_add_u32 v128, 98304, v128
    s_mov_b32 m0, 105024
    s_nop 0
    global_load_lds_dwordx4 v128, s[56:57]
    v_add_u32 v128, 98304, v128
    s_mov_b32 m0, 90688
    s_nop 0
    global_load_lds_dwordx4 v128, s[56:57]
    v_add_u32 v128, 98304, v128
    s_mov_b32 m0, 95808
    s_nop 0
    global_load_lds_dwordx4 v128, s[56:57]
    v_add_u32 v128, 98304, v128
    s_mov_b32 m0, 100928
    s_nop 0
    global_load_lds_dwordx4 v128, s[56:57]
    v_add_u32 v128, 98304, v128
    s_mov_b32 m0, 106048
    s_nop 0
    global_load_lds_dwordx4 v128, s[56:57]
    v_add_u32 v128, 98304, v128
    s_mov_b32 m0, 91712
    s_nop 0
    global_load_lds_dwordx4 v128, s[56:57]
    v_add_u32 v128, 98304, v128
    s_mov_b32 m0, 96832
    s_nop 0
    global_load_lds_dwordx4 v128, s[56:57]
    v_add_u32 v128, 98304, v128
L_ne_58:
    s_barrier
    s_barrier
    s_barrier
    s_cmp_lt_u32 s5, 20
    s_cbranch_scc1 L_ne_59
    s_mov_b32 m0, 101952
    s_nop 0
    global_load_lds_dwordx4 v128, s[56:57]
    v_add_u32 v128, 98304, v128
    s_mov_b32 m0, 107072
    s_nop 0
    global_load_lds_dwordx4 v128, s[56:57]
    v_add_u32 v128, 98304, v128
    s_mov_b32 m0, 92736
    s_nop 0
    global_load_lds_dwordx4 v128, s[56:57]
    v_add_u32 v128, 98304, v128
    s_mov_b32 m0, 97856
    s_nop 0
    global_load_lds_dwordx4 v128, s[56:57]
    v_add_u32 v128, 98304, v128
    s_mov_b32 m0, 102976
    s_nop 0
    global_load_lds_dwordx4 v128, s[56:57]
    v_add_u32 v128, 98304, v128
    s_mov_b32 m0, 108096
    s_nop 0
    global_load_lds_dwordx4 v128, s[56:57]
    v_add_u32 v128, 98304, v128
    s_mov_b32 m0, 93760
    s_nop 0
    global_load_lds_dwordx4 v128, s[56:57]
    v_add_u32 v128, 98304, v128
    s_mov_b32 m0, 98880
    s_nop 0
    global_load_lds_dwordx4 v128, s[56:57]
    v_add_u32 v128, 98304, v128
    s_mov_b32 m0, 104000
    s_nop 0
    global_load_lds_dwordx4 v128, s[56:57]
    v_add_u32 v128, 98304, v128
    s_mov_b32 m0, 109120
    s_nop 0
    global_load_lds_dwordx4 v128, s[56:57]
    s_mov_b32 m0, 130624
    v_add_u32 v90, 0, v2
    global_load_lds_dwordx4 v90, s[62:63] offset:0
    global_load_lds_dwordx4 v90, s[62:63] offset:1024
    global_load_lds_dwordx4 v90, s[62:63] offset:2048
    global_load_lds_dwordx4 v90, s[62:63] offset:3072
    s_mov_b32 m0, 134720
    v_add_u32 v90, 4096, v2
    global_load_lds_dwordx4 v90, s[62:63] offset:0
    global_load_lds_dwordx4 v90, s[62:63] offset:1024
    global_load_lds_dwordx4 v90, s[62:63] offset:2048
    global_load_lds_dwordx4 v90, s[62:63] offset:3072
    s_mov_b32 m0, 138816
    v_add_u32 v90, 8192, v2
    global_load_lds_dwordx4 v90, s[62:63] offset:0
    global_load_lds_dwordx4 v90, s[62:63] offset:1024
L_ne_59:
L_hend1:
    v_mul_u32_u24 v60, 4224, v1
    v_add_u32 v60, 1064960, v60
    v_add_u32 v61, 270336, v60
    v_mov_b32 v62, 28676
    v_and_b32 v63, 15, v1
    v_lshlrev_b32 v63, 7, v63
    v_add_u32 v63, 524416, v63
    s_movk_i32 s42, 4224
    s_cmp_lt_u32 s5, 20
    s_barrier
    s_waitcnt vmcnt(0)
    s_cbranch_scc1 L_hx1
    s_barrier
    global_load_dwordx2 v[64:65], v60, s[32:33] sc1
    global_load_dwordx2 v[66:67], v61, s[32:33] sc1
    s_mov_b32 s40, 1000000
    s_waitcnt vmcnt(0)
L_pollc_62:
    v_xor_b32 v68, v65, v67
    v_xor_b32 v69, s55, v65
    v_or_b32 v68, v68, v69
    v_cmpx_ne_u32 vcc, 0, v68
    s_cbranch_execnz L_poll_60
L_polld_61:
    s_mov_b64 exec, -1
    v_max_u32 v64, v64, v66
    s_nop 1
    v_max_u32_dpp v64, v64, v64 row_ror:8 row_mask:0xf bank_mask:0xf
    s_nop 1
    v_max_u32_dpp v64, v64, v64 row_ror:4 row_mask:0xf bank_mask:0xf
    s_nop 1
    v_max_u32_dpp v64, v64, v64 row_ror:2 row_mask:0xf bank_mask:0xf
    s_nop 1
    v_max_u32_dpp v64, v64, v64 row_ror:1 row_mask:0xf bank_mask:0xf
    s_mov_b32 exec_lo, 0x00010001
    s_mov_b32 exec_hi, 0x00010001
    ds_max_u32 v62, v64
    s_mov_b64 exec, -1
    s_waitcnt lgkmcnt(0)
    s_barrier
L_hx1:
    s_endpgm
L_idle1:
    s_sub_u32 s42, s5, 22
    s_mul_i32 s47, s42, 96
    s_mul_i32 s43, s4, 384
    s_movk_i32 s46, 0x5556
    s_movk_i32 s7, 2688
    s_mul_i32 s42, s4, 245760
    v_add_u32 v90, s47, v1
    v_add_u32 v90, 0, v90
    v_min_u32 v90, 959, v90
    v_add_u32 v90, 0, v90
    v_mul_u32_u24 v91, s46, v90
    v_lshrrev_b32 v91, 16, v91
    v_lshl_add_u32 v90, v90, 7, s43
    v_mad_u32_u24 v130, v91, s7, v90
    v_add_u32 v90, s47, v1
    v_add_u32 v90, 48, v90
    v_min_u32 v90, 959, v90
    v_add_u32 v90, 0, v90
    v_mul_u32_u24 v91, s46, v90
    v_lshrrev_b32 v91, 16, v91
    v_lshl_add_u32 v90, v90, 7, s43
    v_mad_u32_u24 v131, v91, s7, v90
    v_add_u32 v90, s47, v1
    v_add_u32 v90, 0, v90
    v_min_u32 v90, 959, v90
    v_add_u32 v90, 960, v90
    v_mul_u32_u24 v91, s46, v90
    v_lshrrev_b32 v91, 16, v91
    v_lshl_add_u32 v90, v90, 7, s43
    v_mad_u32_u24 v132, v91, s7, v90
    v_add_u32 v90, s47, v1
    v_add_u32 v90, 48, v90
    v_min_u32 v90, 959, v90
    v_add_u32 v90, 960, v90
    v_mul_u32_u24 v91, s46, v90
    v_lshrrev_b32 v91, 16, v91
    v_lshl_add_u32 v90, v90, 7, s43
    v_mad_u32_u24 v133, v91, s7, v90
    v_add_u32 v90, s47, v1
    v_add_u32 v90, 0, v90
    v_min_u32 v90, 959, v90
    v_add_u32 v90, 960, v90
    v_lshl_add_u32 v134, v90, 7, s42
    v_add_u32 v90, s47, v1
    v_add_u32 v90, 48, v90
    v_min_u32 v90, 959, v90
    v_add_u32 v90, 960, v90
    v_lshl_add_u32 v135, v90, 7, s42
    s_barrier
    s_waitcnt vmcnt(0)
    s_mov_b64 exec, 0xff
    global_load_dword v113, v110, s[32:33] sc1
    s_mov_b64 exec, -1
    s_mov_b32 exec_hi, 0xffff
    global_load_dword v125, v130, s[18:19]
    global_load_dword v125, v131, s[18:19]
    s_mov_b64 exec, -1
    s_barrier
    s_barrier
    s_mov_b32 exec_hi, 0xffff
    global_load_dword v125, v132, s[18:19]
    global_load_dword v125, v133, s[18:19]
    global_load_dword v125, v134, s[22:23]
    global_load_dword v125, v135, s[22:23]
    s_mov_b64 exec, -1
    s_waitcnt vmcnt(2)
    s_mov_b32 m0, 89664
    s_nop 0
    global_load_lds_dwordx4 v128, s[56:57]
    v_add_u32 v128, 98304, v128
    s_mov_b32 m0, 94784
    s_nop 0
    global_load_lds_dwordx4 v128, s[56:57]
    v_add_u32 v128, 98304, v128
    s_mov_b32 m0, 99904
    s_nop 0
    global_load_lds_dwordx4 v128, s[56:57]
    v_add_u32 v128, 98304, v128
    s_mov_b32 m0, 105024
    s_nop 0
    global_load_lds_dwordx4 v128, s[56:57]
    v_add_u32 v128, 98304, v128
    s_mov_b32 m0, 90688
    s_nop 0
    global_load_lds_dwordx4 v128, s[56:57]
    v_add_u32 v128, 98304, v128
    s_mov_b32 m0, 95808
    s_nop 0
    global_load_lds_dwordx4 v128, s[56:57]
    v_add_u32 v128, 98304, v128
    s_mov_b32 m0, 100928
    s_nop 0
    global_load_lds_dwordx4 v128, s[56:57]
    v_add_u32 v128, 98304, v128
    s_mov_b32 m0, 106048
    s_nop 0
    global_load_lds_dwordx4 v128, s[56:57]
    v_add_u32 v128, 98304, v128
    s_mov_b32 m0, 91712
    s_nop 0
    global_load_lds_dwordx4 v128, s[56:57]
    v_add_u32 v128, 98304, v128
    s_mov_b32 m0, 96832
    s_nop 0
    global_load_lds_dwordx4 v128, s[56:57]
    v_add_u32 v128, 98304, v128
    s_mov_b32 m0, 101952
    s_nop 0
    global_load_lds_dwordx4 v128, s[56:57]
    v_add_u32 v128, 98304, v128
    s_mov_b32 m0, 107072
    s_nop 0
    global_load_lds_dwordx4 v128, s[56:57]
    v_add_u32 v128, 98304, v128
    s_mov_b32 m0, 92736
    s_nop 0
    global_load_lds_dwordx4 v128, s[56:57]
    v_add_u32 v128, 98304, v128
    s_mov_b32 m0, 97856
    s_nop 0
    global_load_lds_dwordx4 v128, s[56:57]
    v_add_u32 v128, 98304, v128
    s_mov_b32 m0, 102976
    s_nop 0
    global_load_lds_dwordx4 v128, s[56:57]
    v_add_u32 v128, 98304, v128
    s_mov_b32 m0, 108096
    s_nop 0
    global_load_lds_dwordx4 v128, s[56:57]
    v_add_u32 v128, 98304, v128
    s_barrier
    s_waitcnt vmcnt(0)
    s_mov_b64 exec, 0xff
    s_mov_b32 s40, 1000000
L_can_63:
    global_load_dword v113, v110, s[32:33] sc1
    s_waitcnt vmcnt(0)
    v_cmp_eq_u32 vcc, s55, v113
    s_nop 0
    s_bcnt1_i32_b64 s7, vcc
    s_cmp_ge_u32 s7, 5
    s_cbranch_scc1 L_cand_64
    s_sub_u32 s40, s40, 1
    s_cbranch_scc0 L_can_63
L_cand_64:
    s_mov_b64 exec, -1
    s_barrier
    s_barrier
    s_mov_b32 m0, 93760
    s_nop 0
    global_load_lds_dwordx4 v128, s[56:57]
    v_add_u32 v128, 98304, v128
    s_mov_b32 m0, 98880
    s_nop 0
    global_load_lds_dwordx4 v128, s[56:57]
    v_add_u32 v128, 98304, v128
    s_mov_b32 m0, 104000
    s_nop 0
    global_load_lds_dwordx4 v128, s[56:57]
    v_add_u32 v128, 98304, v128
    s_mov_b32 m0, 109120
    s_nop 0
    global_load_lds_dwordx4 v128, s[56:57]
    s_mov_b32 m0, 130624
    v_add_u32 v90, 0, v2
    global_load_lds_dwordx4 v90, s[62:63] offset:0
    global_load_lds_dwordx4 v90, s[62:63] offset:1024
    global_load_lds_dwordx4 v90, s[62:63] offset:2048
    global_load_lds_dwordx4 v90, s[62:63] offset:3072
    s_mov_b32 m0, 134720
    v_add_u32 v90, 4096, v2
    global_load_lds_dwordx4 v90, s[62:63] offset:0
    global_load_lds_dwordx4 v90, s[62:63] offset:1024
    global_load_lds_dwordx4 v90, s[62:63] offset:2048
    global_load_lds_dwordx4 v90, s[62:63] offset:3072
    s_mov_b32 m0, 138816
    v_add_u32 v90, 8192, v2
    global_load_lds_dwordx4 v90, s[62:63] offset:0
    global_load_lds_dwordx4 v90, s[62:63] offset:1024
    s_branch L_hend1
L_sar_56:
    s_sub_u32 s40, s40, 1
    s_cbranch_scc1 L_sar_56_d
    global_load_dwordx2 v[12:13], v4, s[32:33] offset:0 sc1
    global_load_dwordx2 v[14:15], v4, s[32:33] offset:2048 sc1
    global_load_dwordx2 v[16:17], v5, s[32:33] offset:0 sc1
    global_load_dwordx2 v[18:19], v5, s[32:33] offset:2048 sc1
    global_load_dwordx2 v[20:21], v6, s[32:33] offset:0 sc1
    global_load_dwordx2 v[22:23], v4, s[32:33] offset:256 sc1
    global_load_dwordx2 v[24:25], v4, s[32:33] offset:2304 sc1
    global_load_dwordx2 v[26:27], v5, s[32:33] offset:256 sc1
    global_load_dwordx2 v[28:29], v5, s[32:33] offset:2304 sc1
    global_load_dwordx2 v[30:31], v6, s[32:33] offset:256 sc1
    global_load_dwordx2 v[32:33], v4, s[32:33] offset:512 sc1
    global_load_dwordx2 v[34:35], v4, s[32:33] offset:2560 sc1
    global_load_dwordx2 v[36:37], v5, s[32:33] offset:512 sc1
    global_load_dwordx2 v[38:39], v5, s[32:33] offset:2560 sc1
    global_load_dwordx2 v[40:41], v6, s[32:33] offset:512 sc1
    global_load_dwordx2 v[42:43], v4, s[32:33] offset:768 sc1
    global_load_dwordx2 v[44:45], v4, s[32:33] offset:2816 sc1
    global_load_dwordx2 v[46:47], v5, s[32:33] offset:768 sc1
    global_load_dwordx2 v[48:49], v5, s[32:33] offset:2816 sc1
    global_load_dwordx2 v[50:51], v6, s[32:33] offset:768 sc1
    s_branch L_sac_57
L_poll_60:
    s_sub_u32 s40, s40, 1
    s_cbranch_scc1 L_polld_61
    global_load_dwordx2 v[64:65], v60, s[32:33] sc1
    global_load_dwordx2 v[66:67], v61, s[32:33] sc1
    s_waitcnt vmcnt(0)
    s_branch L_pollc_62

.p2align 8
.type L_tables,@object
L_tables:
.long 0x3fb73fb7,0x3fb73fb7,0x00003fb7,0x00000000,0x3ee23fb7,0xbf94bf94,0x00003ee2,0x00000000
.long 0xbf943fb7,0x3ee23ee2,0x0000bf94,0x00000000,0x00000000,0x00000000,0x00000000,0x00000000
.long 0xbf943fb7,0x3ee23ee2,0x0000bf94,0x00000000,0x3ee23fb7,0xbf94bf94,0x00003ee2,0x00000000
.long 0x3fb73fb7,0x3fb73fb7,0x00003fb7,0x00000000,0x00000000,0x00000000,0x00000000,0x00000000
.long 0x3ee23fb7,0xbf94bf94,0x00003ee2,0x00000000,0xbf943fb7,0x3ee23ee2,0x0000bf94,0x00000000
.long 0xbf943fb7,0x3ee23ee2,0x0000bf94,0x00000000,0x00000000,0x00000000,0x00000000,0x00000000
.long 0x3ee23fb7,0xbf94bf94,0x00003ee2,0x00000000,0x3fb73fb7,0x3fb73fb7,0x00003fb7,0x00000000
.long 0x00000000,0x00000000,0x00000000,0x00000000,0x00000000,0x00000000,0x00000000,0x00000000
.long 0x3fb73fb7,0x3fb73fb7,0x00003fb7,0x00000000,0x00003fae,0xbf57bfae,0x00003f57,0x00000000
.long 0xbfb73f94,0xbee23f94,0x0000bee2,0x00000000,0x00000000,0x00000000,0x00000000,0x00000000
.long 0x00003f57,0x3faebf57,0x0000bfae,0x00000000,0x3fb73ee2,0xbf943ee2,0x0000bf94,0x00000000
.long 0x00000000,0x00000000,0x00000000,0x00000000,0x00000000,0x00000000,0x00000000,0x00000000
.long 0xbfb7bee2,0x3f94bee2,0x00003f94,0x00000000,0x0000bf57,0xbfae3f57,0x00003fae,0x00000000
.long 0x3fb7bf94,0x3ee2bf94,0x00003ee2,0x00000000,0x00000000,0x00000000,0x00000000,0x00000000
.long 0x0000bfae,0x3f573fae,0x0000bf57,0x00000000,0xbfb7bfb7,0xbfb7bfb7,0x0000bfb7,0x00000000
.long 0x00000000,0x00000000,0x00000000,0x00000000,0x00000000,0x00000000,0x00000000,0x00000000
.long 0x3fb73fb7,0x3fb73fb7,0x00003fb7,0x00000000,0xbee23f94,0xbee2bfb7,0x00003f94,0x00000000
.long 0xbf943ee2,0xbf943fb7,0x00003ee2,0x00000000,0x00000000,0x00000000,0x00000000,0x00000000
.long 0x3f94bee2,0x3f94bfb7,0x0000bee2,0x00000000,0x3ee2bf94,0x3ee23fb7,0x0000bf94,0x00000000
.long 0xbfb7bfb7,0xbfb7bfb7,0x0000bfb7,0x00000000,0x00000000,0x00000000,0x00000000,0x00000000
.long 0x3ee2bf94,0x3ee23fb7,0x0000bf94,0x00000000,0x3f94bee2,0x3f94bfb7,0x0000bee2,0x00000000
.long 0xbf943ee2,0xbf943fb7,0x00003ee2,0x00000000,0x00000000,0x00000000,0x00000000,0x00000000
.long 0xbee23f94,0xbee2bfb7,0x00003f94,0x00000000,0x3fb73fb7,0x3fb73fb7,0x00003fb7,0x00000000
.long 0x00000000,0x00000000,0x00000000,0x00000000,0x00000000,0x00000000,0x00000000,0x00000000
.long 0x3fb73fb7,0x3fb73fb7,0x00003fb7,0x00000000,0xbf573f57,0x0000bfae,0x00003fae,0x00000000
.long 0xbee2bee2,0xbfb73f94,0x00003f94,0x00000000,0x00000000,0x00000000,0x00000000,0x00000000
.long 0x3faebfae,0x0000bf57,0x00003f57,0x00000000,0xbf94bf94,0x3fb73ee2,0x00003ee2,0x00000000
.long 0x00000000,0x00000000,0x00000000,0x00000000,0x00000000,0x00000000,0x00000000,0x00000000
.long 0x3f943f94,0xbfb7bee2,0x0000bee2,0x00000000,0xbfae3fae,0x00003f57,0x0000bf57,0x00000000
.long 0x3ee23ee2,0x3fb7bf94,0x0000bf94,0x00000000,0x00000000,0x00000000,0x00000000,0x00000000
.long 0x3f57bf57,0x00003fae,0x0000bfae,0x00000000,0xbfb7bfb7,0xbfb7bfb7,0x0000bfb7,0x00000000
.long 0x00000000,0x00000000,0x00000000,0x00000000,0x00000000,0x00000000,0x00000000,0x00000000
.long 0x80008000,0x80008000,0x00008000,0x00000000,0xbfae8000,0x3f57bf57,0x00003fae,0x00000000
.long 0xbf578000,0xbfae3fae,0x00003f57,0x00000000,0x00000000,0x00000000,0x00000000,0x00000000
.long 0x3f578000,0x3faebfae,0x0000bf57,0x00000000,0x3fae8000,0xbf573f57,0x0000bfae,0x00000000
.long 0x80008000,0x80008000,0x00008000,0x00000000,0x00000000,0x00000000,0x00000000,0x00000000
.long 0xbfae8000,0x3f57bf57,0x00003fae,0x00000000,0xbf578000,0xbfae3fae,0x00003f57,0x00000000
.long 0x3f578000,0x3faebfae,0x0000bf57,0x00000000,0x00000000,0x00000000,0x00000000,0x00000000
.long 0x3fae8000,0xbf573f57,0x0000bfae,0x00000000,0x80008000,0x80008000,0x00008000,0x00000000
.long 0x00000000,0x00000000,0x00000000,0x00000000,0x00000000,0x00000000,0x00000000,0x00000000
.long 0x80008000,0x80008000,0x00008000,0x00000000,0xbfb7bee2,0x3f94bee2,0x00003f94,0x00000000
.long 0x8000bf57,0xbfae3f57,0x00003fae,0x00000000,0x00000000,0x00000000,0x00000000,0x00000000
.long 0x3fb7bf94,0x3ee2bf94,0x00003ee2,0x00000000,0x8000bfae,0x3f573fae,0x0000bf57,0x00000000
.long 0xbfb7bfb7,0xbfb7bfb7,0x0000bfb7,0x00000000,0x00000000,0x00000000,0x00000000,0x00000000
.long 0x8000bfae,0x3f573fae,0x0000bf57,0x00000000,0x3fb7bf94,0x3ee2bf94,0x00003ee2,0x00000000
.long 0x8000bf57,0xbfae3f57,0x00003fae,0x00000000,0x00000000,0x00000000,0x00000000,0x00000000
.long 0xbfb7bee2,0x3f94bee2,0x00003f94,0x00000000,0x80008000,0x80008000,0x00008000,0x00000000
.long 0x00000000,0x00000000,0x00000000,0x00000000,0x00000000,0x00000000,0x00000000,0x00000000
.long 0x80008000,0x80008000,0x00008000,0x00000000,0xbfaebf57,0x3fae8000,0x00003f57,0x00000000
.long 0x3f57bfae,0xbf578000,0x00003fae,0x00000000,0x00000000,0x00000000,0x00000000,0x00000000
.long 0x3f57bfae,0xbf578000,0x00003fae,0x00000000,0xbfaebf57,0x3fae8000,0x00003f57,0x00000000
.long 0x80008000,0x80008000,0x00008000,0x00000000,0x00000000,0x00000000,0x00000000,0x00000000
.long 0x3fae3f57,0xbfae8000,0x0000bf57,0x00000000,0xbf573fae,0x3f578000,0x0000bfae,0x00000000
.long 0xbf573fae,0x3f578000,0x0000bfae,0x00000000,0x00000000,0x00000000,0x00000000,0x00000000
.long 0x3fae3f57,0xbfae8000,0x0000bf57,0x00000000,0x80008000,0x80008000,0x00008000,0x00000000
.long 0x00000000,0x00000000,0x00000000,0x00000000,0x00000000,0x00000000,0x00000000,0x00000000
.long 0x80008000,0x80008000,0x00008000,0x00000000,0xbf94bf94,0x3fb73ee2,0x00003ee2,0x00000000
.long 0x3faebfae,0x8000bf57,0x00003f57,0x00000000,0x00000000,0x00000000,0x00000000,0x00000000
.long 0xbee2bee2,0xbfb73f94,0x00003f94,0x00000000,0xbf573f57,0x8000bfae,0x00003fae,0x00000000
.long 0x3fb73fb7,0x3fb73fb7,0x00003fb7,0x00000000,0x00000000,0x00000000,0x00000000,0x00000000
.long 0xbf573f57,0x8000bfae,0x00003fae,0x00000000,0xbee2bee2,0xbfb73f94,0x00003f94,0x00000000
.long 0x3faebfae,0x8000bf57,0x00003f57,0x00000000,0x00000000,0x00000000,0x00000000,0x00000000
.long 0xbf94bf94,0x3fb73ee2,0x00003ee2,0x00000000,0x80008000,0x80008000,0x00008000,0x00000000
.long 0x00000000,0x00000000,0x00000000,0x00000000,0x00000000,0x00000000,0x00000000,0x00000000
.long 0x3f800000,0x3f800000,0x3f800000,0x3f800000,0x3f800000,0x3f7ff35e,0x3f7fcd79,0x3f7f8e56
.long 0x3f800000,0x3f7fcd79,0x3f7f35f9,0x3f7e39bc,0x3f800000,0x3f800000,0x3f800000,0x3f800000
.long 0x3f800000,0x3f7f8e56,0x3f7e39bc,0x3f7c0361,0x3f800000,0x3f7f35f9,0x3f7cd925,0x3f78ed3c
.long 0x3f800000,0x3f7ec46d,0x3f7b14be,0x3f74fa0b,0x3f800000,0x3f800000,0x3f800000,0x3f800000
.long 0x3f800000,0x3f7e39bc,0x3f78ed3c,0x3f702d4f,0x3f800000,0x3f7d95f4,0x3f766377,0x3f6a8b4b
.long 0x3f800000,0x3f7cd925,0x3f737871,0x3f641901,0x3f800000,0x3f800000,0x3f800000,0x3f800000
.long 0x3f800000,0x3f7c0361,0x3f702d4f,0x3f5cdc29,0x3f800000,0x3f7b14be,0x3f6c835e,0x3f54db31
.long 0x3f800000,0x3f800000,0x3f800000,0x3f800000,0x3f800000,0x3f800000,0x3f800000,0x3f800000
.long 0x3f800000,0x3f800000,0x3f800000,0x3f800000,0x3f7f35f9,0x3f7ec46d,0x3f7e39bc,0x3f7d95f4
.long 0x3f7cd925,0x3f7b14be,0x3f78ed3c,0x3f766377,0x3f800000,0x3f800000,0x3f800000,0x3f800000
.long 0x3f78ed3c,0x3f74fa0b,0x3f702d4f,0x3f6a8b4b,0x3f737871,0x3f6c835e,0x3f641901,0x3f5a46a0
.long 0x3f6c835e,0x3f61c598,0x3f54db31,0x3f45e403,0x3f800000,0x3f800000,0x3f800000,0x3f800000
.long 0x3f641901,0x3f54db31,0x3f42a9f7,0x3f2dc5e3,0x3f5a46a0,0x3f45e403,0x3f2dc5e3,0x3f1260b2
.long 0x3f4f1bbd,0x3f3504f3,0x3f167918,0x3ee87171,0x3f800000,0x3f800000,0x3f800000,0x3f800000
.long 0x3f42a9f7,0x3f226799,0x3efa2c90,0x3ea7bf25,0x3f3504f3,0x3f0e39da,0x3ec3ef15,0x3e47c5c2
.long 0x3f800000,0x3f800000,0x3f800000,0x3f800000,0x3f800000,0x3f800000,0x3f800000,0x3f800000
.long 0x3f800000,0x3f800000,0x3f800000,0x3f800000,0x3f7cd925,0x3f7c0361,0x3f7b14be,0x3f7a0d54
.long 0x3f737871,0x3f702d4f,0x3f6c835e,0x3f687c12,0x3f800000,0x3f800000,0x3f800000,0x3f800000
.long 0x3f641901,0x3f5cdc29,0x3f54db31,0x3f4c1d35,0x3f4f1bbd,0x3f42a9f7,0x3f3504f3,0x3f26423a
.long 0x3f3504f3,0x3f226799,0x3f0e39da,0x3ef15aea,0x3f800000,0x3f800000,0x3f800000,0x3f800000
.long 0x3f167918,0x3efa2c90,0x3ec3ef15,0x3e8afa3e,0x3ee87171,0x3ea7bf25,0x3e47c5c2,0x3d712283
.long 0x3e9e377a,0x3e20305b,0x00000000,0xbe20305b,0x3f800000,0x3f800000,0x3f800000,0x3f800000
.long 0x3e20305b,0xbca0d6d6,0xbe47c5c2,0xbeba9be1,0x00000000,0xbe47c5c2,0xbec3ef15,0xbf0e39da
.long 0x3f800000,0x3f800000,0x3f800000,0x3f800000,0x3f800000,0x3f800000,0x3f800000,0x3f800000
.long 0x3f800000,0x3f800000,0x3f800000,0x3f800000,0x3f78ed3c,0x3f77b493,0x3f766377,0x3f74fa0b
.long 0x3f641901,0x3f5f5be6,0x3f5a46a0,0x3f54db31,0x3f800000,0x3f800000,0x3f800000,0x3f800000
.long 0x3f42a9f7,0x3f3889dc,0x3f2dc5e3,0x3f226799,0x3f167918,0x3f05c277,0x3ee87171,0x3ec3ef15
.long 0x3ec3ef15,0x3e94a031,0x3e47c5c2,0x3dc8bd36,0x3f800000,0x3f800000,0x3f800000,0x3f800000
.long 0x3e20305b,0x3d20cee7,0xbda0af2a,0xbe47c5c2,0xbda0af2a,0xbe5b73dc,0xbeb13641,0xbef15aea
.long 0xbe9e377a,0xbee87171,0xbf167918,0xbf3504f3,0x3f800000,0x3f800000,0x3f800000,0x3f800000
.long 0xbf05c277,0xbf2a0c73,0xbf490a88,0xbf61c598,0xbf3504f3,0xbf54db31,0xbf6c835e,0xbf7b14be
.long 0x3f800000,0x3f800000,0x3f800000,0x3f800000,0x3f800000,0x3f800000,0x3f800000,0x3f800000
.long 0x00000000,0x00000000,0x00000000,0x00000000,0x00000000,0x3ca0d6d6,0x3d20cee7,0x3d712283
.long 0x00000000,0x3d20cee7,0x3da0af2a,0x3df0b772,0x00000000,0x00000000,0x00000000,0x00000000
.long 0x00000000,0x3d712283,0x3df0b772,0x3e3403f1,0x00000000,0x3da0af2a,0x3e20305b,0x3e6f0c4d
.long 0x00000000,0x3dc8bd36,0x3e47c5c2,0x3e94a031,0x00000000,0x00000000,0x00000000,0x00000000
.long 0x00000000,0x3df0b772,0x3e6f0c4d,0x3eb13641,0x00000000,0x3e0c4cf7,0x3e8afa3e,0x3ecd2ef3
.long 0x00000000,0x3e20305b,0x3e9e377a,0x3ee87171,0x00000000,0x00000000,0x00000000,0x00000000
.long 0x00000000,0x3e3403f1,0x3eb13641,0x3f0172c3,0x00000000,0x3e47c5c2,0x3ec3ef15,0x3f0e39da
.long 0x00000000,0x00000000,0x00000000,0x00000000,0x00000000,0x00000000,0x00000000,0x00000000
.long 0x00000000,0x00000000,0x00000000,0x00000000,0x3da0af2a,0x3dc8bd36,0x3df0b772,0x3e0c4cf7
.long 0x3e20305b,0x3e47c5c2,0x3e6f0c4d,0x3e8afa3e,0x00000000,0x00000000,0x00000000,0x00000000
.long 0x3e6f0c4d,0x3e94a031,0x3eb13641,0x3ecd2ef3,0x3e9e377a,0x3ec3ef15,0x3ee87171,0x3f05c277
.long 0x3ec3ef15,0x3ef15aea,0x3f0e39da,0x3f226799,0x00000000,0x00000000,0x00000000,0x00000000
.long 0x3ee87171,0x3f0e39da,0x3f26423a,0x3f3bfc8f,0x3f05c277,0x3f226799,0x3f3bfc8f,0x3f5205d4
.long 0x3f167918,0x3f3504f3,0x3f4f1bbd,0x3f641901,0x00000000,0x00000000,0x00000000,0x00000000
.long 0x3f26423a,0x3f45e403,0x3f5f5be6,0x3f71decf,0x3f3504f3,0x3f54db31,0x3f6c835e,0x3f7b14be
.long 0x00000000,0x00000000,0x00000000,0x00000000,0x00000000,0x00000000,0x00000000,0x00000000
.long 0x00000000,0x00000000,0x00000000,0x00000000,0x3e20305b,0x3e3403f1,0x3e47c5c2,0x3e5b73dc
.long 0x3e9e377a,0x3eb13641,0x3ec3ef15,0x3ed65a92,0x00000000,0x00000000,0x00000000,0x00000000
.long 0x3ee87171,0x3f0172c3,0x3f0e39da,0x3f1a82a4,0x3f167918,0x3f26423a,0x3f3504f3,0x3f42a9f7
.long 0x3f3504f3,0x3f45e403,0x3f54db31,0x3f61c598,0x00000000,0x00000000,0x00000000,0x00000000
.long 0x3f4f1bbd,0x3f5f5be6,0x3f6c835e,0x3f766377,0x3f641901,0x3f71decf,0x3f7b14be,0x3f7f8e56
.long 0x3f737871,0x3f7cd925,0x3f800000,0x3f7cd925,0x00000000,0x00000000,0x00000000,0x00000000
.long 0x3f7cd925,0x3f7ff35e,0x3f7b14be,0x3f6e641a,0x3f800000,0x3f7b14be,0x3f6c835e,0x3f54db31
.long 0x00000000,0x00000000,0x00000000,0x00000000,0x00000000,0x00000000,0x00000000,0x00000000
.long 0x00000000,0x00000000,0x00000000,0x00000000,0x3e6f0c4d,0x3e814693,0x3e8afa3e,0x3e94a031
.long 0x3ee87171,0x3efa2c90,0x3f05c277,0x3f0e39da,0x00000000,0x00000000,0x00000000,0x00000000
.long 0x3f26423a,0x3f316e2c,0x3f3bfc8f,0x3f45e403,0x3f4f1bbd,0x3f5a46a0,0x3f641901,0x3f6c835e
.long 0x3f6c835e,0x3f74fa0b,0x3f7b14be,0x3f7ec46d,0x00000000,0x00000000,0x00000000,0x00000000
.long 0x3f7cd925,0x3f7fcd79,0x3f7f35f9,0x3f7b14be,0x3f7f35f9,0x3f7a0d54,0x3f702d4f,0x3f61c598
.long 0x3f737871,0x3f641901,0x3f4f1bbd,0x3f3504f3,0x00000000,0x00000000,0x00000000,0x00000000
.long 0x3f5a46a0,0x3f3f5cb5,0x3f1e7cf1,0x3ef15aea,0x3f3504f3,0x3f0e39da,0x3ec3ef15,0x3e47c5c2
.long 0x00000000,0x00000000,0x00000000,0x00000000,0x00000000,0x00000000,0x00000000,0x00000000
.long 0x3f800000,0x3f800000,0x3f800000,0x3f800000,0x3f7ffcd7,0x3f7fe394,0x3f7fb10f,0x3f7f654e
.long 0x3f7ff35e,0x3f7f8e56,0x3f7ec46d,0x3f7d95f4,0x3f800000,0x3f800000,0x3f800000,0x3f800000
.long 0x3f7fe394,0x3f7f0059,0x3f7d3aac,0x3f7a9421,0x3f7fcd79,0x3f7e39bc,0x3f7b14be,0x3f766377
.long 0x3f7fb10f,0x3f7d3aac,0x3f7853f8,0x3f710908,0x3f800000,0x3f800000,0x3f800000,0x3f800000
.long 0x3f7f8e56,0x3f7c0361,0x3f74fa0b,0x3f6a8b4b,0x3f7f654e,0x3f7a9421,0x3f710908,0x3f62f219
.long 0x3f7f35f9,0x3f78ed3c,0x3f6c835e,0x3f5a46a0,0x3f800000,0x3f800000,0x3f800000,0x3f800000
.long 0x3f7f0059,0x3f770f11,0x3f676bd8,0x3f50935b,0x3f7ec46d,0x3f74fa0b,0x3f61c598,0x3f45e403
.long 0x3f800000,0x3f800000,0x3f800000,0x3f800000,0x3f800000,0x3f800000,0x3f800000,0x3f800000
.long 0x3f800000,0x3f800000,0x3f800000,0x3f800000,0x3f7f0059,0x3f7e8238,0x3f7deafa,0x3f7d3aac
.long 0x3f7c0361,0x3f7a0d54,0x3f77b493,0x3f74fa0b,0x3f800000,0x3f800000,0x3f800000,0x3f800000
.long 0x3f770f11,0x3f72ae9e,0x3f6d76aa,0x3f676bd8,0x3f702d4f,0x3f687c12,0x3f5f5be6,0x3f54db31
.long 0x3f676bd8,0x3f5b941a,0x3f4d9f02,0x3f3daef9,0x3f800000,0x3f800000,0x3f800000,0x3f800000
.long 0x3f5cdc29,0x3f4c1d35,0x3f3889dc,0x3f226799,0x3f50935b,0x3f3a4582,0x3f207440,0x3f039c3d
.long 0x3f42a9f7,0x3f26423a,0x3f05c277,0x3ec3ef15,0x3f800000,0x3f800000,0x3f800000,0x3f800000
.long 0x3f333bc6,0x3f104f0e,0x3ed1c759,0x3e78cfcc,0x3f226799,0x3ef15aea,0x3e94a031,0x3dc8bd36
.long 0x3f800000,0x3f800000,0x3f800000,0x3f800000,0x3f800000,0x3f800000,0x3f800000,0x3f800000
.long 0x3f800000,0x3f800000,0x3f800000,0x3f800000,0x3f7c7160,0x3f7b8f2a,0x3f7a9421,0x3f79805c
.long 0x3f71decf,0x3f6e641a,0x3f6a8b4b,0x3f6655e7,0x3f800000,0x3f800000,0x3f800000,0x3f800000
.long 0x3f609384,0x3f58f3c4,0x3f50935b,0x3f4779bc,0x3f490a88,0x3f3bfc8f,0x3f2dc5e3,0x3f1e7cf1
.long 0x3f2beb4a,0x3f187fc0,0x3f039c3d,0x3edae880,0x3f800000,0x3f800000,0x3f800000,0x3f800000
.long 0x3f0a04f8,0x3edf7108,0x3ea7bf25,0x3e5b73dc,0x3ec8917e,0x3e862210,0x3e0255f4,0xbc20d8d2
.long 0x3e6f0c4d,0x3da0af2a,0xbda0af2a,0xbe6f0c4d,0x3f800000,0x3f800000,0x3f800000,0x3f800000
.long 0x3d8ca1f2,0xbddcbd0d,0xbe8fcefe,0xbee3f40d,0xbdc8bd36,0xbe94a031,0xbef15aea,0xbf226799
.long 0x3f800000,0x3f800000,0x3f800000,0x3f800000,0x3f800000,0x3f800000,0x3f800000,0x3f800000
.long 0x3f800000,0x3f800000,0x3f800000,0x3f800000,0x3f7853f8,0x3f770f11,0x3f75b1c9,0x3f743c41
.long 0x3f61c598,0x3f5cdc29,0x3f579b8c,0x3f5205d4,0x3f800000,0x3f800000,0x3f800000,0x3f800000
.long 0x3f3daef9,0x3f333bc6,0x3f28296a,0x3f1c81b9,0x3f0e39da,0x3efa2c90,0x3ed65a92,0x3eb13641
.long 0x3eac7cd4,0x3e78cfcc,0x3e164083,0x3d48fb30,0x3f800000,0x3f800000,0x3f800000,0x3f800000
.long 0x3dc8bd36,0xbca0d6d6,0xbe0c4cf7,0xbe814693,0xbe164083,0xbe8fcefe,0xbed1c759,0xbf07e565
.long 0xbec3ef15,0xbf05c277,0xbf26423a,0xbf42a9f7,0x3f800000,0x3f800000,0x3f800000,0x3f800000
.long 0xbf187fc0,0xbf3a4582,0xbf563e03,0xbf6b8a3d,0xbf45e403,0xbf61c598,0xbf74fa0b,0xbf7ec46d
.long 0x3f800000,0x3f800000,0x3f800000,0x3f800000,0x3f800000,0x3f800000,0x3f800000,0x3f800000
.long 0x00000000,0x00000000,0x00000000,0x00000000,0x3c20d8d2,0x3cf13d4c,0x3d48fb30,0x3d8ca1f2
.long 0x3ca0d6d6,0x3d712283,0x3dc8bd36,0x3e0c4cf7,0x00000000,0x00000000,0x00000000,0x00000000
.long 0x3cf13d4c,0x3db4b86a,0x3e164083,0x3e519f65,0x3d20cee7,0x3df0b772,0x3e47c5c2,0x3e8afa3e
.long 0x3d48fb30,0x3e164083,0x3e78cfcc,0x3eac7cd4,0x00000000,0x00000000,0x00000000,0x00000000
.long 0x3d712283,0x3e3403f1,0x3e94a031,0x3ecd2ef3,0x3d8ca1f2,0x3e519f65,0x3eac7cd4,0x3eece91a
.long 0x3da0af2a,0x3e6f0c4d,0x3ec3ef15,0x3f05c277,0x00000000,0x00000000,0x00000000,0x00000000
.long 0x3db4b86a,0x3e862210,0x3edae880,0x3f146eba,0x3dc8bd36,0x3e94a031,0x3ef15aea,0x3f226799
.long 0x00000000,0x00000000,0x00000000,0x00000000,0x00000000,0x00000000,0x00000000,0x00000000
.long 0x00000000,0x00000000,0x00000000,0x00000000,0x3db4b86a,0x3ddcbd0d,0x3e0255f4,0x3e164083
.long 0x3e3403f1,0x3e5b73dc,0x3e814693,0x3e94a031,0x00000000,0x00000000,0x00000000,0x00000000
.long 0x3e862210,0x3ea2fd52,0x3ebf47d7,0x3edae880,0x3eb13641,0x3ed65a92,0x3efa2c90,0x3f0e39da
.long 0x3edae880,0x3f039c3d,0x3f187fc0,0x3f2beb4a,0x00000000,0x00000000,0x00000000,0x00000000
.long 0x3f0172c3,0x3f1a82a4,0x3f316e2c,0x3f45e403,0x3f146eba,0x3f2f9c32,0x3f4779bc,0x3f5b941a
.long 0x3f26423a,0x3f42a9f7,0x3f5a46a0,0x3f6c835e,0x00000000,0x00000000,0x00000000,0x00000000
.long 0x3f36c9a9,0x3f53731f,0x3f698690,0x3f7853f8,0x3f45e403,0x3f61c598,0x3f74fa0b,0x3f7ec46d
.long 0x00000000,0x00000000,0x00000000,0x00000000,0x00000000,0x00000000,0x00000000,0x00000000
.long 0x00000000,0x00000000,0x00000000,0x00000000,0x3e2a1c3f,0x3e3de731,0x3e519f65,0x3e6542e9
.long 0x3ea7bf25,0x3eba9be1,0x3ecd2ef3,0x3edf7108,0x00000000,0x00000000,0x00000000,0x00000000
.long 0x3ef5c6c5,0x3f07e565,0x3f146eba,0x3f207440,0x3f1e7cf1,0x3f2dc5e3,0x3f3bfc8f,0x3f490a88
.long 0x3f3daef9,0x3f4d9f02,0x3f5b941a,0x3f676bd8,0x00000000,0x00000000,0x00000000,0x00000000
.long 0x3f579b8c,0x3f6655e7,0x3f71decf,0x3f7a0d54,0x3f6b8a3d,0x3f770f11,0x3f7deafa,0x3f7ffcd7
.long 0x3f78ed3c,0x3f7f35f9,0x3f7f35f9,0x3f78ed3c,0x00000000,0x00000000,0x00000000,0x00000000
.long 0x3f7f654e,0x3f7e8238,0x3f75b1c9,0x3f653a48,0x3f7ec46d,0x3f74fa0b,0x3f61c598,0x3f45e403
.long 0x00000000,0x00000000,0x00000000,0x00000000,0x00000000,0x00000000,0x00000000,0x00000000
.long 0x00000000,0x00000000,0x00000000,0x00000000,0x3e78cfcc,0x3e862210,0x3e8fcefe,0x3e996dba
.long 0x3ef15aea,0x3f0172c3,0x3f0a04f8,0x3f1260b2,0x00000000,0x00000000,0x00000000,0x00000000
.long 0x3f2beb4a,0x3f36c9a9,0x3f4105b8,0x3f4a965e,0x3f54db31,0x3f5f5be6,0x3f687c12,0x3f702d4f
.long 0x3f710908,0x3f7853f8,0x3f7d3aac,0x3f7fb10f,0x00000000,0x00000000,0x00000000,0x00000000
.long 0x3f7ec46d,0x3f7ff35e,0x3f7d95f4,0x3f77b493,0x3f7d3aac,0x3f75b1c9,0x3f698690,0x3f58f3c4
.long 0x3f6c835e,0x3f5a46a0,0x3f42a9f7,0x3f26423a,0x00000000,0x00000000,0x00000000,0x00000000
.long 0x3f4d9f02,0x3f2f9c32,0x3f0c2124,0x3ec8917e,0x3f226799,0x3ef15aea,0x3e94a031,0x3dc8bd36
.long 0x00000000,0x00000000,0x00000000,0x00000000,0x00000000,0x00000000,0x00000000,0x00000000
.long 0x00003fd0,0x00003fd0,0x00003fd0,0x00003fd0,0x00003fd0,0x3f933f93,0x3fd00000,0x3f93bf93
.long 0x00003fd0,0x3fd00000,0x0000bfd0,0xbfd00000,0x00003fd0,0x3f93bf93,0xbfd00000,0x3f933f93
.long 0x00003fd0,0x0000bfd0,0x00003fd0,0x0000bfd0,0x00003fd0,0xbf93bf93,0x3fd00000,0xbf933f93
.long 0x00003fd0,0xbfd00000,0x0000bfd0,0x3fd00000,0x00003fd0,0xbf933f93,0xbfd00000,0xbf93bf93
.long 0x00003fd0,0xbf1f3fc0,0xbf933f93,0xbfc03f1f,0x00003fd0,0xbfc03f1f,0xbf93bf93,0x3f1fbfc0
.long 0x00003fd0,0xbfc0bf1f,0x3f93bf93,0x3f1f3fc0,0x00003fd0,0xbf1fbfc0,0x3f933f93,0xbfc0bf1f
.long 0x00003fd0,0x3f1fbfc0,0xbf933f93,0x3fc0bf1f,0x00003fd0,0x3fc0bf1f,0xbf93bf93,0xbf1f3fc0
.long 0x00003fd0,0x3fc03f1f,0x3f93bf93,0xbf1fbfc0,0x00003fd0,0x3f1f3fc0,0x3f933f93,0x3fc03f1f
.long 0x00003fd0,0x00003fd0,0x00003fd0,0x00003fd0,0x0000bfd0,0xbf93bf93,0xbfd00000,0xbf933f93
.long 0x00003fd0,0x3fd00000,0x0000bfd0,0xbfd00000,0x0000bfd0,0xbf933f93,0x3fd00000,0xbf93bf93
.long 0x00003fd0,0x0000bfd0,0x00003fd0,0x0000bfd0,0x0000bfd0,0x3f933f93,0xbfd00000,0x3f93bf93
.long 0x00003fd0,0xbfd00000,0x0000bfd0,0x3fd00000,0x0000bfd0,0x3f93bf93,0x3fd00000,0x3f933f93
.long 0xbfd00000,0xbfc0bf1f,0xbf93bf93,0xbf1fbfc0,0x3fd00000,0x3f1f3fc0,0xbf933f93,0xbfc0bf1f
.long 0xbfd00000,0x3f1fbfc0,0x3f933f93,0xbfc03f1f,0x3fd00000,0xbfc03f1f,0x3f93bf93,0xbf1f3fc0
.long 0xbfd00000,0x3fc03f1f,0xbf93bf93,0x3f1f3fc0,0x3fd00000,0xbf1fbfc0,0xbf933f93,0x3fc03f1f
.long 0xbfd00000,0xbf1f3fc0,0x3f933f93,0x3fc0bf1f,0x3fd00000,0x3fc0bf1f,0x3f93bf93,0x3f1fbfc0
.long 0x00003fd0,0x00003fd0,0x00003fd0,0x00003fd0,0x00003fd0,0x3f933f93,0x3fd00000,0x3f93bf93
.long 0x00003fd0,0x3fd00000,0x0000bfd0,0xbfd00000,0x00003fd0,0x3f93bf93,0xbfd00000,0x3f933f93
.long 0x00003fd0,0x0000bfd0,0x00003fd0,0x0000bfd0,0x00003fd0,0xbf93bf93,0x3fd00000,0xbf933f93
.long 0x00003fd0,0xbfd00000,0x0000bfd0,0x3fd00000,0x00003fd0,0xbf933f93,0xbfd00000,0xbf93bf93
.long 0x0000bfd0,0x3f1fbfc0,0x3f93bf93,0x3fc0bf1f,0x0000bfd0,0x3fc0bf1f,0x3f933f93,0xbf1f3fc0
.long 0x0000bfd0,0x3fc03f1f,0xbf933f93,0xbf1fbfc0,0x0000bfd0,0x3f1f3fc0,0xbf93bf93,0x3fc03f1f
.long 0x0000bfd0,0xbf1f3fc0,0x3f93bf93,0xbfc03f1f,0x0000bfd0,0xbfc03f1f,0x3f933f93,0x3f1fbfc0
.long 0x0000bfd0,0xbfc0bf1f,0xbf933f93,0x3f1f3fc0,0x0000bfd0,0xbf1fbfc0,0xbf93bf93,0xbfc0bf1f
.long 0x00003fd0,0x00003fd0,0x00003fd0,0x00003fd0,0x0000bfd0,0xbf93bf93,0xbfd00000,0xbf933f93
.long 0x00003fd0,0x3fd00000,0x0000bfd0,0xbfd00000,0x0000bfd0,0xbf933f93,0x3fd00000,0xbf93bf93
.long 0x00003fd0,0x0000bfd0,0x00003fd0,0x0000bfd0,0x0000bfd0,0x3f933f93,0xbfd00000,0x3f93bf93
.long 0x00003fd0,0xbfd00000,0x0000bfd0,0x3fd00000,0x0000bfd0,0x3f93bf93,0x3fd00000,0x3f933f93
.long 0x3fd00000,0x3fc03f1f,0x3f933f93,0x3f1f3fc0,0xbfd00000,0xbf1fbfc0,0x3f93bf93,0x3fc03f1f
.long 0x3fd00000,0xbf1f3fc0,0xbf93bf93,0x3fc0bf1f,0xbfd00000,0x3fc0bf1f,0xbf933f93,0x3f1fbfc0
.long 0x3fd00000,0xbfc0bf1f,0x3f933f93,0xbf1fbfc0,0xbfd00000,0x3f1f3fc0,0x3f93bf93,0xbfc0bf1f
.long 0x3fd00000,0x3f1fbfc0,0xbf93bf93,0xbfc03f1f,0xbfd00000,0xbfc03f1f,0xbf933f93,0xbf1f3fc0
.long 0x00003fd0,0x00003fd0,0x00003fd0,0x00003fd0,0x3f1f3fc0,0x3fc03f1f,0x3fc0bf1f,0x3f1fbfc0
.long 0x3f933f93,0x3f93bf93,0xbf93bf93,0xbf933f93,0x3fc03f1f,0xbf1fbfc0,0xbf1f3fc0,0x3fc0bf1f
.long 0x3fd00000,0xbfd00000,0x3fd00000,0xbfd00000,0x3fc0bf1f,0xbf1f3fc0,0xbf1fbfc0,0x3fc03f1f
.long 0x3f93bf93,0x3f933f93,0xbf933f93,0xbf93bf93,0x3f1fbfc0,0x3fc0bf1f,0x3fc03f1f,0x3f1f3fc0
.long 0xbea23fcc,0xbf673fad,0xbfad3f67,0xbfcc3ea2,0xbf673fad,0xbfccbea2,0xbea2bfcc,0x3fadbf67
.long 0xbfad3f67,0xbea2bfcc,0x3fcc3ea2,0xbf673fad,0xbfcc3ea2,0x3fadbf67,0xbf673fad,0x3ea2bfcc
.long 0xbfccbea2,0x3fad3f67,0xbf67bfad,0x3ea23fcc,0xbfadbf67,0xbea23fcc,0x3fccbea2,0xbf67bfad
.long 0xbf67bfad,0xbfcc3ea2,0xbea23fcc,0x3fad3f67,0xbea2bfcc,0xbf67bfad,0xbfadbf67,0xbfccbea2
.long 0x00003fd0,0x00003fd0,0x00003fd0,0x00003fd0,0xbf1fbfc0,0xbfc0bf1f,0xbfc03f1f,0xbf1f3fc0
.long 0x3f933f93,0x3f93bf93,0xbf93bf93,0xbf933f93,0xbfc0bf1f,0x3f1f3fc0,0x3f1fbfc0,0xbfc03f1f
.long 0x3fd00000,0xbfd00000,0x3fd00000,0xbfd00000,0xbfc03f1f,0x3f1fbfc0,0x3f1f3fc0,0xbfc0bf1f
.long 0x3f93bf93,0x3f933f93,0xbf933f93,0xbf93bf93,0xbf1f3fc0,0xbfc03f1f,0xbfc0bf1f,0xbf1fbfc0
.long 0xbfccbea2,0xbfadbf67,0xbf67bfad,0xbea2bfcc,0x3fad3f67,0xbea23fcc,0xbfcc3ea2,0xbf67bfad
.long 0xbf67bfad,0x3fccbea2,0xbea23fcc,0xbfadbf67,0x3ea23fcc,0xbf67bfad,0x3fad3f67,0xbfccbea2
.long 0x3ea2bfcc,0xbf673fad,0x3fadbf67,0xbfcc3ea2,0xbf673fad,0x3fcc3ea2,0xbea2bfcc,0xbfad3f67
.long 0x3fadbf67,0xbea2bfcc,0xbfccbea2,0xbf673fad,0xbfcc3ea2,0xbfad3f67,0xbf673fad,0xbea23fcc
.long 0x00003fd0,0x00003fd0,0x00003fd0,0x00003fd0,0x3f1f3fc0,0x3fc03f1f,0x3fc0bf1f,0x3f1fbfc0
.long 0x3f933f93,0x3f93bf93,0xbf93bf93,0xbf933f93,0x3fc03f1f,0xbf1fbfc0,0xbf1f3fc0,0x3fc0bf1f
.long 0x3fd00000,0xbfd00000,0x3fd00000,0xbfd00000,0x3fc0bf1f,0xbf1f3fc0,0xbf1fbfc0,0x3fc03f1f
.long 0x3f93bf93,0x3f933f93,0xbf933f93,0xbf93bf93,0x3f1fbfc0,0x3fc0bf1f,0x3fc03f1f,0x3f1f3fc0
.long 0x3ea2bfcc,0x3f67bfad,0x3fadbf67,0x3fccbea2,0x3f67bfad,0x3fcc3ea2,0x3ea23fcc,0xbfad3f67
.long 0x3fadbf67,0x3ea23fcc,0xbfccbea2,0x3f67bfad,0x3fccbea2,0xbfad3f67,0x3f67bfad,0xbea23fcc
.long 0x3fcc3ea2,0xbfadbf67,0x3f673fad,0xbea2bfcc,0x3fad3f67,0x3ea2bfcc,0xbfcc3ea2,0x3f673fad
.long 0x3f673fad,0x3fccbea2,0x3ea2bfcc,0xbfadbf67,0x3ea23fcc,0x3f673fad,0x3fad3f67,0x3fcc3ea2
.long 0x00003fd0,0x00003fd0,0x00003fd0,0x00003fd0,0xbf1fbfc0,0xbfc0bf1f,0xbfc03f1f,0xbf1f3fc0
.long 0x3f933f93,0x3f93bf93,0xbf93bf93,0xbf933f93,0xbfc0bf1f,0x3f1f3fc0,0x3f1fbfc0,0xbfc03f1f
.long 0x3fd00000,0xbfd00000,0x3fd00000,0xbfd00000,0xbfc03f1f,0x3f1fbfc0,0x3f1f3fc0,0xbfc0bf1f
.long 0x3f93bf93,0x3f933f93,0xbf933f93,0xbf93bf93,0xbf1f3fc0,0xbfc03f1f,0xbfc0bf1f,0xbf1fbfc0
.long 0x3fcc3ea2,0x3fad3f67,0x3f673fad,0x3ea23fcc,0xbfadbf67,0x3ea2bfcc,0x3fccbea2,0x3f673fad
.long 0x3f673fad,0xbfcc3ea2,0x3ea2bfcc,0x3fad3f67,0xbea2bfcc,0x3f673fad,0xbfadbf67,0x3fcc3ea2
.long 0xbea23fcc,0x3f67bfad,0xbfad3f67,0x3fccbea2,0x3f67bfad,0xbfccbea2,0x3ea23fcc,0x3fadbf67
.long 0xbfad3f67,0x3ea23fcc,0x3fcc3ea2,0x3f67bfad,0x3fccbea2,0x3fadbf67,0x3f67bfad,0x3ea2bfcc
.long 0x00003fd0,0x3f1f3fc0,0x3f933f93,0x3fc03f1f,0x00003fd0,0x3fc03f1f,0x3f93bf93,0xbf1fbfc0
.long 0x00003fd0,0x3fc0bf1f,0xbf93bf93,0xbf1f3fc0,0x00003fd0,0x3f1fbfc0,0xbf933f93,0x3fc0bf1f
.long 0x00003fd0,0xbf1fbfc0,0x3f933f93,0xbfc0bf1f,0x00003fd0,0xbfc0bf1f,0x3f93bf93,0x3f1f3fc0
.long 0x00003fd0,0xbfc03f1f,0xbf93bf93,0x3f1fbfc0,0x00003fd0,0xbf1f3fc0,0xbf933f93,0xbfc03f1f
.long 0x00003fd0,0xbf933f93,0xbfd00000,0xbf93bf93,0x00003fd0,0xbfd00000,0x0000bfd0,0x3fd00000
.long 0x00003fd0,0xbf93bf93,0x3fd00000,0xbf933f93,0x00003fd0,0x0000bfd0,0x00003fd0,0x0000bfd0
.long 0x00003fd0,0x3f93bf93,0xbfd00000,0x3f933f93,0x00003fd0,0x3fd00000,0x0000bfd0,0xbfd00000
.long 0x00003fd0,0x3f933f93,0x3fd00000,0x3f93bf93,0x00003fd0,0x00003fd0,0x00003fd0,0x00003fd0
.long 0x3fd00000,0x3fc0bf1f,0x3f93bf93,0x3f1fbfc0,0xbfd00000,0xbf1f3fc0,0x3f933f93,0x3fc0bf1f
.long 0x3fd00000,0xbf1fbfc0,0xbf933f93,0x3fc03f1f,0xbfd00000,0x3fc03f1f,0xbf93bf93,0x3f1f3fc0
.long 0x3fd00000,0xbfc03f1f,0x3f93bf93,0xbf1f3fc0,0xbfd00000,0x3f1fbfc0,0x3f933f93,0xbfc03f1f
.long 0x3fd00000,0x3f1f3fc0,0xbf933f93,0xbfc0bf1f,0xbfd00000,0xbfc0bf1f,0xbf93bf93,0xbf1fbfc0
.long 0x0000bfd0,0x3f93bf93,0x3fd00000,0x3f933f93,0x00003fd0,0xbfd00000,0x0000bfd0,0x3fd00000
.long 0x0000bfd0,0x3f933f93,0xbfd00000,0x3f93bf93,0x00003fd0,0x0000bfd0,0x00003fd0,0x0000bfd0
.long 0x0000bfd0,0xbf933f93,0x3fd00000,0xbf93bf93,0x00003fd0,0x3fd00000,0x0000bfd0,0xbfd00000
.long 0x0000bfd0,0xbf93bf93,0xbfd00000,0xbf933f93,0x00003fd0,0x00003fd0,0x00003fd0,0x00003fd0
.long 0x0000bfd0,0xbf1fbfc0,0xbf93bf93,0xbfc0bf1f,0x0000bfd0,0xbfc0bf1f,0xbf933f93,0x3f1f3fc0
.long 0x0000bfd0,0xbfc03f1f,0x3f933f93,0x3f1fbfc0,0x0000bfd0,0xbf1f3fc0,0x3f93bf93,0xbfc03f1f
.long 0x0000bfd0,0x3f1f3fc0,0xbf93bf93,0x3fc03f1f,0x0000bfd0,0x3fc03f1f,0xbf933f93,0xbf1fbfc0
.long 0x0000bfd0,0x3fc0bf1f,0x3f933f93,0xbf1f3fc0,0x0000bfd0,0x3f1fbfc0,0x3f93bf93,0x3fc0bf1f
.long 0x00003fd0,0xbf933f93,0xbfd00000,0xbf93bf93,0x00003fd0,0xbfd00000,0x0000bfd0,0x3fd00000
.long 0x00003fd0,0xbf93bf93,0x3fd00000,0xbf933f93,0x00003fd0,0x0000bfd0,0x00003fd0,0x0000bfd0
.long 0x00003fd0,0x3f93bf93,0xbfd00000,0x3f933f93,0x00003fd0,0x3fd00000,0x0000bfd0,0xbfd00000
.long 0x00003fd0,0x3f933f93,0x3fd00000,0x3f93bf93,0x00003fd0,0x00003fd0,0x00003fd0,0x00003fd0
.long 0xbfd00000,0xbfc03f1f,0xbf933f93,0xbf1f3fc0,0x3fd00000,0x3f1fbfc0,0xbf93bf93,0xbfc03f1f
.long 0xbfd00000,0x3f1f3fc0,0x3f93bf93,0xbfc0bf1f,0x3fd00000,0xbfc0bf1f,0x3f933f93,0xbf1fbfc0
.long 0xbfd00000,0x3fc0bf1f,0xbf933f93,0x3f1fbfc0,0x3fd00000,0xbf1f3fc0,0xbf93bf93,0x3fc0bf1f
.long 0xbfd00000,0xbf1fbfc0,0x3f93bf93,0x3fc03f1f,0x3fd00000,0x3fc03f1f,0x3f933f93,0x3f1f3fc0
.long 0x0000bfd0,0x3f93bf93,0x3fd00000,0x3f933f93,0x00003fd0,0xbfd00000,0x0000bfd0,0x3fd00000
.long 0x0000bfd0,0x3f933f93,0xbfd00000,0x3f93bf93,0x00003fd0,0x0000bfd0,0x00003fd0,0x0000bfd0
.long 0x0000bfd0,0xbf933f93,0x3fd00000,0xbf93bf93,0x00003fd0,0x3fd00000,0x0000bfd0,0xbfd00000
.long 0x0000bfd0,0xbf93bf93,0xbfd00000,0xbf933f93,0x00003fd0,0x00003fd0,0x00003fd0,0x00003fd0
.long 0x3ea23fcc,0x3f673fad,0x3fad3f67,0x3fcc3ea2,0x3f673fad,0x3fccbea2,0x3ea2bfcc,0xbfadbf67
.long 0x3fad3f67,0x3ea2bfcc,0xbfcc3ea2,0x3f673fad,0x3fcc3ea2,0xbfadbf67,0x3f673fad,0xbea2bfcc
.long 0x3fccbea2,0xbfad3f67,0x3f67bfad,0xbea23fcc,0x3fadbf67,0x3ea23fcc,0xbfccbea2,0x3f67bfad
.long 0x3f67bfad,0x3fcc3ea2,0x3ea23fcc,0xbfad3f67,0x3ea2bfcc,0x3f67bfad,0x3fadbf67,0x3fccbea2
.long 0xbf1f3fc0,0xbfc03f1f,0xbfc0bf1f,0xbf1fbfc0,0xbf933f93,0xbf93bf93,0x3f93bf93,0x3f933f93
.long 0xbfc03f1f,0x3f1fbfc0,0x3f1f3fc0,0xbfc0bf1f,0xbfd00000,0x3fd00000,0xbfd00000,0x3fd00000
.long 0xbfc0bf1f,0x3f1f3fc0,0x3f1fbfc0,0xbfc03f1f,0xbf93bf93,0xbf933f93,0x3f933f93,0x3f93bf93
.long 0xbf1fbfc0,0xbfc0bf1f,0xbfc03f1f,0xbf1f3fc0,0x0000bfd0,0x0000bfd0,0x0000bfd0,0x0000bfd0
.long 0x3fccbea2,0x3fadbf67,0x3f67bfad,0x3ea2bfcc,0xbfad3f67,0x3ea23fcc,0x3fcc3ea2,0x3f67bfad
.long 0x3f67bfad,0xbfccbea2,0x3ea23fcc,0x3fadbf67,0xbea23fcc,0x3f67bfad,0xbfad3f67,0x3fccbea2
.long 0xbea2bfcc,0x3f673fad,0xbfadbf67,0x3fcc3ea2,0x3f673fad,0xbfcc3ea2,0x3ea2bfcc,0x3fad3f67
.long 0xbfadbf67,0x3ea2bfcc,0x3fccbea2,0x3f673fad,0x3fcc3ea2,0x3fad3f67,0x3f673fad,0x3ea23fcc
.long 0x3f1fbfc0,0x3fc0bf1f,0x3fc03f1f,0x3f1f3fc0,0xbf933f93,0xbf93bf93,0x3f93bf93,0x3f933f93
.long 0x3fc0bf1f,0xbf1f3fc0,0xbf1fbfc0,0x3fc03f1f,0xbfd00000,0x3fd00000,0xbfd00000,0x3fd00000
.long 0x3fc03f1f,0xbf1fbfc0,0xbf1f3fc0,0x3fc0bf1f,0xbf93bf93,0xbf933f93,0x3f933f93,0x3f93bf93
.long 0x3f1f3fc0,0x3fc03f1f,0x3fc0bf1f,0x3f1fbfc0,0x0000bfd0,0x0000bfd0,0x0000bfd0,0x0000bfd0
.long 0xbea2bfcc,0xbf67bfad,0xbfadbf67,0xbfccbea2,0xbf67bfad,0xbfcc3ea2,0xbea23fcc,0x3fad3f67
.long 0xbfadbf67,0xbea23fcc,0x3fccbea2,0xbf67bfad,0xbfccbea2,0x3fad3f67,0xbf67bfad,0x3ea23fcc
.long 0xbfcc3ea2,0x3fadbf67,0xbf673fad,0x3ea2bfcc,0xbfad3f67,0xbea2bfcc,0x3fcc3ea2,0xbf673fad
.long 0xbf673fad,0xbfccbea2,0xbea2bfcc,0x3fadbf67,0xbea23fcc,0xbf673fad,0xbfad3f67,0xbfcc3ea2
.long 0xbf1f3fc0,0xbfc03f1f,0xbfc0bf1f,0xbf1fbfc0,0xbf933f93,0xbf93bf93,0x3f93bf93,0x3f933f93
.long 0xbfc03f1f,0x3f1fbfc0,0x3f1f3fc0,0xbfc0bf1f,0xbfd00000,0x3fd00000,0xbfd00000,0x3fd00000
.long 0xbfc0bf1f,0x3f1f3fc0,0x3f1fbfc0,0xbfc03f1f,0xbf93bf93,0xbf933f93,0x3f933f93,0x3f93bf93
.long 0xbf1fbfc0,0xbfc0bf1f,0xbfc03f1f,0xbf1f3fc0,0x0000bfd0,0x0000bfd0,0x0000bfd0,0x0000bfd0
.long 0xbfcc3ea2,0xbfad3f67,0xbf673fad,0xbea23fcc,0x3fadbf67,0xbea2bfcc,0xbfccbea2,0xbf673fad
.long 0xbf673fad,0x3fcc3ea2,0xbea2bfcc,0xbfad3f67,0x3ea2bfcc,0xbf673fad,0x3fadbf67,0xbfcc3ea2
.long 0x3ea23fcc,0xbf67bfad,0x3fad3f67,0xbfccbea2,0xbf67bfad,0x3fccbea2,0xbea23fcc,0xbfadbf67
.long 0x3fad3f67,0xbea23fcc,0xbfcc3ea2,0xbf67bfad,0xbfccbea2,0xbfadbf67,0xbf67bfad,0xbea2bfcc
.long 0x3f1fbfc0,0x3fc0bf1f,0x3fc03f1f,0x3f1f3fc0,0xbf933f93,0xbf93bf93,0x3f93bf93,0x3f933f93
.long 0x3fc0bf1f,0xbf1f3fc0,0xbf1fbfc0,0x3fc03f1f,0xbfd00000,0x3fd00000,0xbfd00000,0x3fd00000
.long 0x3fc03f1f,0xbf1fbfc0,0xbf1f3fc0,0x3fc0bf1f,0xbf93bf93,0xbf933f93,0x3f933f93,0x3f93bf93
.long 0x3f1f3fc0,0x3fc03f1f,0x3fc0bf1f,0x3f1fbfc0,0x0000bfd0,0x0000bfd0,0x0000bfd0,0x0000bfd0
.long 0x00000000,0x00008000,0x00000000,0x00008000,0x00000008,0x00008000,0x00000000,0x00008000
.long 0x00000010,0x00008000,0x00000000,0x00008000,0x00000000,0x00008000,0x00000000,0x00008000
.long 0x00000018,0x00008000,0x00000000,0x00008000,0x00000020,0x00008000,0x00000000,0x00008000
.long 0x00000028,0x00008000,0x00000000,0x00008000,0x00000000,0x00008000,0x00000000,0x00008000
.long 0x00000030,0x80000000,0x00000000,0x00008000,0x00000038,0x80000000,0x00000000,0x00008000
.long 0x00000040,0x80000000,0x00000000,0x00008000,0x00000000,0x80000000,0x00000000,0x00008000
.long 0x00000048,0x80000000,0x00000000,0x00008000,0x00000050,0x80000000,0x00000000,0x00008000
.long 0x00000000,0x80000000,0x00000000,0x00008000,0x00000000,0x80000000,0x00000000,0x00008000
.long 0x00000500,0x00008000,0x00000000,0x00008000,0x00000508,0x00008000,0x00000000,0x00008000
.long 0x00000510,0x00008000,0x00000000,0x00008000,0x00000000,0x00008000,0x00000000,0x00008000
.long 0x00000518,0x00008000,0x00000000,0x00008000,0x00000520,0x00008000,0x00000000,0x00008000
.long 0x00000528,0x00008000,0x00000000,0x00008000,0x00000000,0x00008000,0x00000000,0x00008000
.long 0x00000530,0x80000000,0x00000000,0x00008000,0x00000538,0x80000000,0x00000000,0x00008000
.long 0x00000540,0x80000000,0x00000000,0x00008000,0x00000000,0x80000000,0x00000000,0x00008000
.long 0x00000548,0x80000000,0x00000000,0x00008000,0x00000550,0x80000000,0x00000000,0x00008000
.long 0x00000000,0x80000000,0x00000000,0x00008000,0x00000000,0x80000000,0x00000000,0x00008000
.long 0x000000a0,0x00008000,0x00008000,0x00000000,0x00000098,0x00008000,0x00008000,0x00000000
.long 0x00000090,0x00008000,0x00008000,0x00000000,0x00000000,0x00008000,0x00008000,0x00000000
.long 0x00000088,0x00008000,0x00008000,0x00000000,0x00000080,0x00008000,0x00008000,0x00000000
.long 0x00000078,0x00008000,0x00008000,0x00000000,0x00000000,0x00008000,0x00008000,0x00000000
.long 0x00000070,0x80000000,0x00008000,0x00000000,0x00000068,0x80000000,0x00008000,0x00000000
.long 0x00000060,0x80000000,0x00008000,0x00000000,0x00000000,0x80000000,0x00008000,0x00000000
.long 0x00000058,0x80000000,0x00008000,0x00000000,0x00000050,0x80000000,0x00008000,0x00000000
.long 0x00000000,0x80000000,0x00008000,0x00000000,0x00000000,0x80000000,0x00008000,0x00000000
.long 0x000005a0,0x00008000,0x00008000,0x00000000,0x00000598,0x00008000,0x00008000,0x00000000
.long 0x00000590,0x00008000,0x00008000,0x00000000,0x00000000,0x00008000,0x00008000,0x00000000
.long 0x00000588,0x00008000,0x00008000,0x00000000,0x00000580,0x00008000,0x00008000,0x00000000
.long 0x00000578,0x00008000,0x00008000,0x00000000,0x00000000,0x00008000,0x00008000,0x00000000
.long 0x00000570,0x80000000,0x00008000,0x00000000,0x00000568,0x80000000,0x00008000,0x00000000
.long 0x00000560,0x80000000,0x00008000,0x00000000,0x00000000,0x80000000,0x00008000,0x00000000
.long 0x00000558,0x80000000,0x00008000,0x00000000,0x00000550,0x80000000,0x00008000,0x00000000
.long 0x00000000,0x80000000,0x00008000,0x00000000,0x00000000,0x80000000,0x00008000,0x00000000
.long 0x3f800000,0x3f800000,0x3f800000,0x3f800000,0x3f800000,0x3f7ff35e,0x3f7fcd79,0x3f800000
.long 0x3f800000,0x3f7fcd79,0x3f7f35f9,0x3f800000,0x3f800000,0x3f7f8e56,0x3f7e39bc,0x3f800000
.long 0x3f800000,0x3f7f35f9,0x3f7cd925,0x3f800000,0x3f800000,0x3f7ec46d,0x3f7b14be,0x3f800000
.long 0x3f800000,0x3f7e39bc,0x3f78ed3c,0x3f800000,0x3f800000,0x3f7d95f4,0x3f766377,0x3f800000
.long 0x3f800000,0x3f7cd925,0x3f737871,0x3f800000,0x3f800000,0x3f7c0361,0x3f702d4f,0x3f800000
.long 0x3f800000,0x3f7b14be,0x3f6c835e,0x3f800000,0x3f800000,0x3f7a0d54,0x3f687c12,0x3f800000
.long 0x3f800000,0x3f78ed3c,0x3f641901,0x3f800000,0x3f800000,0x3f77b493,0x3f5f5be6,0x3f800000
.long 0x3f800000,0x3f766377,0x3f5a46a0,0x3f800000,0x3f800000,0x3f74fa0b,0x3f54db31,0x3f800000
.long 0x3f800000,0x3f800000,0x3f800000,0x3f800000,0x3f7f8e56,0x3f7f35f9,0x3f7ec46d,0x3f800000
.long 0x3f7e39bc,0x3f7cd925,0x3f7b14be,0x3f800000,0x3f7c0361,0x3f78ed3c,0x3f74fa0b,0x3f800000
.long 0x3f78ed3c,0x3f737871,0x3f6c835e,0x3f800000,0x3f74fa0b,0x3f6c835e,0x3f61c598,0x3f800000
.long 0x3f702d4f,0x3f641901,0x3f54db31,0x3f800000,0x3f6a8b4b,0x3f5a46a0,0x3f45e403,0x3f800000
.long 0x3f641901,0x3f4f1bbd,0x3f3504f3,0x3f800000,0x3f5cdc29,0x3f42a9f7,0x3f226799,0x3f800000
.long 0x3f54db31,0x3f3504f3,0x3f0e39da,0x3f800000,0x3f4c1d35,0x3f26423a,0x3ef15aea,0x3f800000
.long 0x3f42a9f7,0x3f167918,0x3ec3ef15,0x3f800000,0x3f3889dc,0x3f05c277,0x3e94a031,0x3f800000
.long 0x3f2dc5e3,0x3ee87171,0x3e47c5c2,0x3f800000,0x3f226799,0x3ec3ef15,0x3dc8bd36,0x3f800000
.long 0x3f800000,0x3f800000,0x3f800000,0x3f800000,0x3f7e39bc,0x3f7d95f4,0x3f7cd925,0x3f800000
.long 0x3f78ed3c,0x3f766377,0x3f737871,0x3f800000,0x3f702d4f,0x3f6a8b4b,0x3f641901,0x3f800000
.long 0x3f641901,0x3f5a46a0,0x3f4f1bbd,0x3f800000,0x3f54db31,0x3f45e403,0x3f3504f3,0x3f800000
.long 0x3f42a9f7,0x3f2dc5e3,0x3f167918,0x3f800000,0x3f2dc5e3,0x3f1260b2,0x3ee87171,0x3f800000
.long 0x3f167918,0x3ee87171,0x3e9e377a,0x3f800000,0x3efa2c90,0x3ea7bf25,0x3e20305b,0x3f800000
.long 0x3ec3ef15,0x3e47c5c2,0x00000000,0x3f800000,0x3e8afa3e,0x3d712283,0xbe20305b,0x3f800000
.long 0x3e20305b,0xbda0af2a,0xbe9e377a,0x3f800000,0x3d20cee7,0xbe5b73dc,0xbee87171,0x3f800000
.long 0xbda0af2a,0xbeb13641,0xbf167918,0x3f800000,0xbe47c5c2,0xbef15aea,0xbf3504f3,0x3f800000
.long 0x3f800000,0x3f800000,0x3f800000,0x3f800000,0x3f7c0361,0x3f7b14be,0x3f800000,0x3f800000
.long 0x3f702d4f,0x3f6c835e,0x3f800000,0x3f800000,0x3f5cdc29,0x3f54db31,0x3f800000,0x3f800000
.long 0x3f42a9f7,0x3f3504f3,0x3f800000,0x3f800000,0x3f226799,0x3f0e39da,0x3f800000,0x3f800000
.long 0x3efa2c90,0x3ec3ef15,0x3f800000,0x3f800000,0x3ea7bf25,0x3e47c5c2,0x3f800000,0x3f800000
.long 0x3e20305b,0x00000000,0x3f800000,0x3f800000,0xbca0d6d6,0xbe47c5c2,0x3f800000,0x3f800000
.long 0xbe47c5c2,0xbec3ef15,0x3f800000,0x3f800000,0xbeba9be1,0xbf0e39da,0x3f800000,0x3f800000
.long 0xbf05c277,0xbf3504f3,0x3f800000,0x3f800000,0xbf2a0c73,0xbf54db31,0x3f800000,0x3f800000
.long 0xbf490a88,0xbf6c835e,0x3f800000,0x3f800000,0xbf61c598,0xbf7b14be,0x3f800000,0x3f800000
.long 0x00000000,0x00000000,0x00000000,0x00000000,0x00000000,0x3ca0d6d6,0x3d20cee7,0x00000000
.long 0x00000000,0x3d20cee7,0x3da0af2a,0x00000000,0x00000000,0x3d712283,0x3df0b772,0x00000000
.long 0x00000000,0x3da0af2a,0x3e20305b,0x00000000,0x00000000,0x3dc8bd36,0x3e47c5c2,0x00000000
.long 0x00000000,0x3df0b772,0x3e6f0c4d,0x00000000,0x00000000,0x3e0c4cf7,0x3e8afa3e,0x00000000
.long 0x00000000,0x3e20305b,0x3e9e377a,0x00000000,0x00000000,0x3e3403f1,0x3eb13641,0x00000000
.long 0x00000000,0x3e47c5c2,0x3ec3ef15,0x00000000,0x00000000,0x3e5b73dc,0x3ed65a92,0x00000000
.long 0x00000000,0x3e6f0c4d,0x3ee87171,0x00000000,0x00000000,0x3e814693,0x3efa2c90,0x00000000
.long 0x00000000,0x3e8afa3e,0x3f05c277,0x00000000,0x00000000,0x3e94a031,0x3f0e39da,0x00000000
.long 0x00000000,0x00000000,0x00000000,0x00000000,0x3d712283,0x3da0af2a,0x3dc8bd36,0x00000000
.long 0x3df0b772,0x3e20305b,0x3e47c5c2,0x00000000,0x3e3403f1,0x3e6f0c4d,0x3e94a031,0x00000000
.long 0x3e6f0c4d,0x3e9e377a,0x3ec3ef15,0x00000000,0x3e94a031,0x3ec3ef15,0x3ef15aea,0x00000000
.long 0x3eb13641,0x3ee87171,0x3f0e39da,0x00000000,0x3ecd2ef3,0x3f05c277,0x3f226799,0x00000000
.long 0x3ee87171,0x3f167918,0x3f3504f3,0x00000000,0x3f0172c3,0x3f26423a,0x3f45e403,0x00000000
.long 0x3f0e39da,0x3f3504f3,0x3f54db31,0x00000000,0x3f1a82a4,0x3f42a9f7,0x3f61c598,0x00000000
.long 0x3f26423a,0x3f4f1bbd,0x3f6c835e,0x00000000,0x3f316e2c,0x3f5a46a0,0x3f74fa0b,0x00000000
.long 0x3f3bfc8f,0x3f641901,0x3f7b14be,0x00000000,0x3f45e403,0x3f6c835e,0x3f7ec46d,0x00000000
.long 0x00000000,0x00000000,0x00000000,0x00000000,0x3df0b772,0x3e0c4cf7,0x3e20305b,0x00000000
.long 0x3e6f0c4d,0x3e8afa3e,0x3e9e377a,0x00000000,0x3eb13641,0x3ecd2ef3,0x3ee87171,0x00000000
.long 0x3ee87171,0x3f05c277,0x3f167918,0x00000000,0x3f0e39da,0x3f226799,0x3f3504f3,0x00000000
.long 0x3f26423a,0x3f3bfc8f,0x3f4f1bbd,0x00000000,0x3f3bfc8f,0x3f5205d4,0x3f641901,0x00000000
.long 0x3f4f1bbd,0x3f641901,0x3f737871,0x00000000,0x3f5f5be6,0x3f71decf,0x3f7cd925,0x00000000
.long 0x3f6c835e,0x3f7b14be,0x3f800000,0x00000000,0x3f766377,0x3f7f8e56,0x3f7cd925,0x00000000
.long 0x3f7cd925,0x3f7f35f9,0x3f737871,0x00000000,0x3f7fcd79,0x3f7a0d54,0x3f641901,0x00000000
.long 0x3f7f35f9,0x3f702d4f,0x3f4f1bbd,0x00000000,0x3f7b14be,0x3f61c598,0x3f3504f3,0x00000000
.long 0x00000000,0x00000000,0x00000000,0x00000000,0x3e3403f1,0x3e47c5c2,0x00000000,0x00000000
.long 0x3eb13641,0x3ec3ef15,0x00000000,0x00000000,0x3f0172c3,0x3f0e39da,0x00000000,0x00000000
.long 0x3f26423a,0x3f3504f3,0x00000000,0x00000000,0x3f45e403,0x3f54db31,0x00000000,0x00000000
.long 0x3f5f5be6,0x3f6c835e,0x00000000,0x00000000,0x3f71decf,0x3f7b14be,0x00000000,0x00000000
.long 0x3f7cd925,0x3f800000,0x00000000,0x00000000,0x3f7ff35e,0x3f7b14be,0x00000000,0x00000000
.long 0x3f7b14be,0x3f6c835e,0x00000000,0x00000000,0x3f6e641a,0x3f54db31,0x00000000,0x00000000
.long 0x3f5a46a0,0x3f3504f3,0x00000000,0x00000000,0x3f3f5cb5,0x3f0e39da,0x00000000,0x00000000
.long 0x3f1e7cf1,0x3ec3ef15,0x00000000,0x00000000,0x3ef15aea,0x3e47c5c2,0x00000000,0x00000000
.long 0x3f800000,0x3f7ffcd7,0x3f7ff35e,0x3f800000,0x3f800000,0x3f7fe394,0x3f7f8e56,0x3f800000
.long 0x3f800000,0x3f7fb10f,0x3f7ec46d,0x3f800000,0x3f800000,0x3f7f654e,0x3f7d95f4,0x3f800000
.long 0x3f800000,0x3f7f0059,0x3f7c0361,0x3f800000,0x3f800000,0x3f7e8238,0x3f7a0d54,0x3f800000
.long 0x3f800000,0x3f7deafa,0x3f77b493,0x3f800000,0x3f800000,0x3f7d3aac,0x3f74fa0b,0x3f800000
.long 0x3f800000,0x3f7c7160,0x3f71decf,0x3f800000,0x3f800000,0x3f7b8f2a,0x3f6e641a,0x3f800000
.long 0x3f800000,0x3f7a9421,0x3f6a8b4b,0x3f800000,0x3f800000,0x3f79805c,0x3f6655e7,0x3f800000
.long 0x3f800000,0x3f7853f8,0x3f61c598,0x3f800000,0x3f800000,0x3f770f11,0x3f5cdc29,0x3f800000
.long 0x3f800000,0x3f75b1c9,0x3f579b8c,0x3f800000,0x3f800000,0x3f743c41,0x3f5205d4,0x3f800000
.long 0x3f7fe394,0x3f7fcd79,0x3f7fb10f,0x3f800000,0x3f7f0059,0x3f7e39bc,0x3f7d3aac,0x3f800000
.long 0x3f7d3aac,0x3f7b14be,0x3f7853f8,0x3f800000,0x3f7a9421,0x3f766377,0x3f710908,0x3f800000
.long 0x3f770f11,0x3f702d4f,0x3f676bd8,0x3f800000,0x3f72ae9e,0x3f687c12,0x3f5b941a,0x3f800000
.long 0x3f6d76aa,0x3f5f5be6,0x3f4d9f02,0x3f800000,0x3f676bd8,0x3f54db31,0x3f3daef9,0x3f800000
.long 0x3f609384,0x3f490a88,0x3f2beb4a,0x3f800000,0x3f58f3c4,0x3f3bfc8f,0x3f187fc0,0x3f800000
.long 0x3f50935b,0x3f2dc5e3,0x3f039c3d,0x3f800000,0x3f4779bc,0x3f1e7cf1,0x3edae880,0x3f800000
.long 0x3f3daef9,0x3f0e39da,0x3eac7cd4,0x3f800000,0x3f333bc6,0x3efa2c90,0x3e78cfcc,0x3f800000
.long 0x3f28296a,0x3ed65a92,0x3e164083,0x3f800000,0x3f1c81b9,0x3eb13641,0x3d48fb30,0x3f800000
.long 0x3f7f8e56,0x3f7f654e,0x3f7f35f9,0x3f800000,0x3f7c0361,0x3f7a9421,0x3f78ed3c,0x3f800000
.long 0x3f74fa0b,0x3f710908,0x3f6c835e,0x3f800000,0x3f6a8b4b,0x3f62f219,0x3f5a46a0,0x3f800000
.long 0x3f5cdc29,0x3f50935b,0x3f42a9f7,0x3f800000,0x3f4c1d35,0x3f3a4582,0x3f26423a,0x3f800000
.long 0x3f3889dc,0x3f207440,0x3f05c277,0x3f800000,0x3f226799,0x3f039c3d,0x3ec3ef15,0x3f800000
.long 0x3f0a04f8,0x3ec8917e,0x3e6f0c4d,0x3f800000,0x3edf7108,0x3e862210,0x3da0af2a,0x3f800000
.long 0x3ea7bf25,0x3e0255f4,0xbda0af2a,0x3f800000,0x3e5b73dc,0xbc20d8d2,0xbe6f0c4d,0x3f800000
.long 0x3dc8bd36,0xbe164083,0xbec3ef15,0x3f800000,0xbca0d6d6,0xbe8fcefe,0xbf05c277,0x3f800000
.long 0xbe0c4cf7,0xbed1c759,0xbf26423a,0x3f800000,0xbe814693,0xbf07e565,0xbf42a9f7,0x3f800000
.long 0x3f7f0059,0x3f7ec46d,0x3f800000,0x3f800000,0x3f770f11,0x3f74fa0b,0x3f800000,0x3f800000
.long 0x3f676bd8,0x3f61c598,0x3f800000,0x3f800000,0x3f50935b,0x3f45e403,0x3f800000,0x3f800000
.long 0x3f333bc6,0x3f226799,0x3f800000,0x3f800000,0x3f104f0e,0x3ef15aea,0x3f800000,0x3f800000
.long 0x3ed1c759,0x3e94a031,0x3f800000,0x3f800000,0x3e78cfcc,0x3dc8bd36,0x3f800000,0x3f800000
.long 0x3d8ca1f2,0xbdc8bd36,0x3f800000,0x3f800000,0xbddcbd0d,0xbe94a031,0x3f800000,0x3f800000
.long 0xbe8fcefe,0xbef15aea,0x3f800000,0x3f800000,0xbee3f40d,0xbf226799,0x3f800000,0x3f800000
.long 0xbf187fc0,0xbf45e403,0x3f800000,0x3f800000,0xbf3a4582,0xbf61c598,0x3f800000,0x3f800000
.long 0xbf563e03,0xbf74fa0b,0x3f800000,0x3f800000,0xbf6b8a3d,0xbf7ec46d,0x3f800000,0x3f800000
.long 0x00000000,0x3c20d8d2,0x3ca0d6d6,0x00000000,0x00000000,0x3cf13d4c,0x3d712283,0x00000000
.long 0x00000000,0x3d48fb30,0x3dc8bd36,0x00000000,0x00000000,0x3d8ca1f2,0x3e0c4cf7,0x00000000
.long 0x00000000,0x3db4b86a,0x3e3403f1,0x00000000,0x00000000,0x3ddcbd0d,0x3e5b73dc,0x00000000
.long 0x00000000,0x3e0255f4,0x3e814693,0x00000000,0x00000000,0x3e164083,0x3e94a031,0x00000000
.long 0x00000000,0x3e2a1c3f,0x3ea7bf25,0x00000000,0x00000000,0x3e3de731,0x3eba9be1,0x00000000
.long 0x00000000,0x3e519f65,0x3ecd2ef3,0x00000000,0x00000000,0x3e6542e9,0x3edf7108,0x00000000
.long 0x00000000,0x3e78cfcc,0x3ef15aea,0x00000000,0x00000000,0x3e862210,0x3f0172c3,0x00000000
.long 0x00000000,0x3e8fcefe,0x3f0a04f8,0x00000000,0x00000000,0x3e996dba,0x3f1260b2,0x00000000
.long 0x3cf13d4c,0x3d20cee7,0x3d48fb30,0x00000000,0x3db4b86a,0x3df0b772,0x3e164083,0x00000000
.long 0x3e164083,0x3e47c5c2,0x3e78cfcc,0x00000000,0x3e519f65,0x3e8afa3e,0x3eac7cd4,0x00000000
.long 0x3e862210,0x3eb13641,0x3edae880,0x00000000,0x3ea2fd52,0x3ed65a92,0x3f039c3d,0x00000000
.long 0x3ebf47d7,0x3efa2c90,0x3f187fc0,0x00000000,0x3edae880,0x3f0e39da,0x3f2beb4a,0x00000000
.long 0x3ef5c6c5,0x3f1e7cf1,0x3f3daef9,0x00000000,0x3f07e565,0x3f2dc5e3,0x3f4d9f02,0x00000000
.long 0x3f146eba,0x3f3bfc8f,0x3f5b941a,0x00000000,0x3f207440,0x3f490a88,0x3f676bd8,0x00000000
.long 0x3f2beb4a,0x3f54db31,0x3f710908,0x00000000,0x3f36c9a9,0x3f5f5be6,0x3f7853f8,0x00000000
.long 0x3f4105b8,0x3f687c12,0x3f7d3aac,0x00000000,0x3f4a965e,0x3f702d4f,0x3f7fb10f,0x00000000
.long 0x3d712283,0x3d8ca1f2,0x3da0af2a,0x00000000,0x3e3403f1,0x3e519f65,0x3e6f0c4d,0x00000000
.long 0x3e94a031,0x3eac7cd4,0x3ec3ef15,0x00000000,0x3ecd2ef3,0x3eece91a,0x3f05c277,0x00000000
.long 0x3f0172c3,0x3f146eba,0x3f26423a,0x00000000,0x3f1a82a4,0x3f2f9c32,0x3f42a9f7,0x00000000
.long 0x3f316e2c,0x3f4779bc,0x3f5a46a0,0x00000000,0x3f45e403,0x3f5b941a,0x3f6c835e,0x00000000
.long 0x3f579b8c,0x3f6b8a3d,0x3f78ed3c,0x00000000,0x3f6655e7,0x3f770f11,0x3f7f35f9,0x00000000
.long 0x3f71decf,0x3f7deafa,0x3f7f35f9,0x00000000,0x3f7a0d54,0x3f7ffcd7,0x3f78ed3c,0x00000000
.long 0x3f7ec46d,0x3f7d3aac,0x3f6c835e,0x00000000,0x3f7ff35e,0x3f75b1c9,0x3f5a46a0,0x00000000
.long 0x3f7d95f4,0x3f698690,0x3f42a9f7,0x00000000,0x3f77b493,0x3f58f3c4,0x3f26423a,0x00000000
.long 0x3db4b86a,0x3dc8bd36,0x00000000,0x00000000,0x3e862210,0x3e94a031,0x00000000,0x00000000
.long 0x3edae880,0x3ef15aea,0x00000000,0x00000000,0x3f146eba,0x3f226799,0x00000000,0x00000000
.long 0x3f36c9a9,0x3f45e403,0x00000000,0x00000000,0x3f53731f,0x3f61c598,0x00000000,0x00000000
.long 0x3f698690,0x3f74fa0b,0x00000000,0x00000000,0x3f7853f8,0x3f7ec46d,0x00000000,0x00000000
.long 0x3f7f654e,0x3f7ec46d,0x00000000,0x00000000,0x3f7e8238,0x3f74fa0b,0x00000000,0x00000000
.long 0x3f75b1c9,0x3f61c598,0x00000000,0x00000000,0x3f653a48,0x3f45e403,0x00000000,0x00000000
.long 0x3f4d9f02,0x3f226799,0x00000000,0x00000000,0x3f2f9c32,0x3ef15aea,0x00000000,0x00000000
.long 0x3f0c2124,0x3e94a031,0x00000000,0x00000000,0x3ec8917e,0x3dc8bd36,0x00000000,0x00000000
.long 0x80003fb7,0x80003fb7,0x80003fb7,0x00000000,0x80003fb7,0xbfae3ee2,0xbf57bf94,0x00000000
.long 0x80003fb7,0xbf57bf94,0x3fae3ee2,0x00000000,0x80003fb7,0x3f57bf94,0xbfae3ee2,0x00000000
.long 0x80003fb7,0xbee23fae,0xbf573f94,0x00000000,0x80003fb7,0xbfb70000,0x8000bfb7,0x00000000
.long 0x80003fb7,0xbee2bfae,0x3f573f94,0x00000000,0x80003fb7,0x3f94bf57,0xbfaebee2,0x00000000
.long 0x80003fb7,0xbf573f94,0xbfae3ee2,0x00000000,0x80003fb7,0xbfaebee2,0x3f57bf94,0x00000000
.long 0x80003fb7,0x8000bfb7,0x80003fb7,0x00000000,0x80003fb7,0x3faebee2,0xbf57bf94,0x00000000
.long 0x80003fb7,0xbf943f57,0xbfaebee2,0x00000000,0x80003fb7,0xbf94bf57,0x3faebee2,0x00000000
.long 0x80003fb7,0x3ee2bfae,0xbf573f94,0x00000000,0x80003fb7,0x3fb70000,0x8000bfb7,0x00000000
.long 0x80003fb7,0x80003fb7,0x80003fb7,0x00000000,0x3f57bf94,0x3fae3ee2,0x80003fb7,0x00000000
.long 0xbfae3ee2,0x3f57bf94,0x80003fb7,0x00000000,0x3fae3ee2,0xbf57bf94,0x80003fb7,0x00000000
.long 0xbf943f57,0xbfae3ee2,0xbfb70000,0x00000000,0x3fb70000,0x80003fb7,0xbfb70000,0x00000000
.long 0xbf94bf57,0x3fae3ee2,0xbfb70000,0x00000000,0x3ee23fae,0x3f57bf94,0xbfb70000,0x00000000
.long 0xbfaebee2,0xbf57bf94,0x8000bfb7,0x00000000,0x3f573f94,0xbfae3ee2,0x8000bfb7,0x00000000
.long 0x8000bfb7,0x80003fb7,0x8000bfb7,0x00000000,0xbf573f94,0x3fae3ee2,0x8000bfb7,0x00000000
.long 0xbee2bfae,0x3f57bf94,0x3fb70000,0x00000000,0xbee23fae,0xbf57bf94,0x3fb70000,0x00000000
.long 0x3f94bf57,0xbfae3ee2,0x3fb70000,0x00000000,0xbfb70000,0x80003fb7,0x3fb70000,0x00000000
.long 0x80003fb7,0x80003fb7,0x80003fb7,0x00000000,0xbfae3ee2,0xbf57bf94,0x3f57bf94,0x00000000
.long 0xbf57bf94,0x3fae3ee2,0xbfae3ee2,0x00000000,0x3f57bf94,0xbfae3ee2,0x3fae3ee2,0x00000000
.long 0xbfaebee2,0xbf94bf57,0xbf57bf94,0x00000000,0x8000bfb7,0x3fb70000,0x80003fb7,0x00000000
.long 0x3faebee2,0xbf943f57,0x3f57bf94,0x00000000,0x3f573f94,0x3ee2bfae,0xbfae3ee2,0x00000000
.long 0x3f57bf94,0x3faebee2,0x3fae3ee2,0x00000000,0x3fae3ee2,0xbf573f94,0xbf57bf94,0x00000000
.long 0x80003fb7,0x8000bfb7,0x80003fb7,0x00000000,0xbfae3ee2,0x3f573f94,0x3f57bf94,0x00000000
.long 0x3f573f94,0xbee23fae,0xbfae3ee2,0x00000000,0xbf573f94,0xbee2bfae,0x3fae3ee2,0x00000000
.long 0xbfaebee2,0x3f943f57,0xbf57bf94,0x00000000,0x8000bfb7,0xbfb70000,0x80003fb7,0x00000000
.long 0x80003fb7,0x80003fb7,0x00000000,0x00000000,0x3fae3ee2,0x80003fb7,0x00000000,0x00000000
.long 0x3f57bf94,0x80003fb7,0x00000000,0x00000000,0xbf57bf94,0x80003fb7,0x00000000,0x00000000
.long 0xbee2bfae,0x8000bfb7,0x00000000,0x00000000,0xbfb70000,0x8000bfb7,0x00000000,0x00000000
.long 0xbee23fae,0x8000bfb7,0x00000000,0x00000000,0x3f943f57,0x8000bfb7,0x00000000,0x00000000
.long 0x3f573f94,0x80003fb7,0x00000000,0x00000000,0x3faebee2,0x80003fb7,0x00000000,0x00000000
.long 0x8000bfb7,0x80003fb7,0x00000000,0x00000000,0xbfaebee2,0x80003fb7,0x00000000,0x00000000
.long 0xbf94bf57,0x8000bfb7,0x00000000,0x00000000,0xbf943f57,0x8000bfb7,0x00000000,0x00000000
.long 0x3ee23fae,0x8000bfb7,0x00000000,0x00000000,0x3fb70000,0x8000bfb7,0x00000000,0x00000000
.long 0x80003fb7,0x3fae3ee2,0x3f57bf94,0x00000000,0x00000000,0x00000000,0x00000000,0x00000000
.long 0x00000000,0x00000000,0x00000000,0x00000000,0x00000000,0x00000000,0x00000000,0x00000000
.long 0x80003fb7,0x3f943f57,0x3faebee2,0x00000000,0x00000000,0x00000000,0x00000000,0x00000000
.long 0x00000000,0x00000000,0x00000000,0x00000000,0x00000000,0x00000000,0x00000000,0x00000000
.long 0x80003fb7,0x3f573f94,0x3fae3ee2,0x00000000,0x00000000,0x00000000,0x00000000,0x00000000
.long 0x00000000,0x00000000,0x00000000,0x00000000,0x00000000,0x00000000,0x00000000,0x00000000
.long 0x80003fb7,0x3ee23fae,0x3f573f94,0x00000000,0x00000000,0x00000000,0x00000000,0x00000000
.long 0x00000000,0x00000000,0x00000000,0x00000000,0x00000000,0x00000000,0x00000000,0x00000000
.long 0xbf57bf94,0xbfae3ee2,0x80003fb7,0x00000000,0x00000000,0x00000000,0x00000000,0x00000000
.long 0x00000000,0x00000000,0x00000000,0x00000000,0x00000000,0x00000000,0x00000000,0x00000000
.long 0x3ee2bfae,0xbf57bf94,0xbfb70000,0x00000000,0x00000000,0x00000000,0x00000000,0x00000000
.long 0x00000000,0x00000000,0x00000000,0x00000000,0x00000000,0x00000000,0x00000000,0x00000000
.long 0x3faebee2,0x3f57bf94,0x8000bfb7,0x00000000,0x00000000,0x00000000,0x00000000,0x00000000
.long 0x00000000,0x00000000,0x00000000,0x00000000,0x00000000,0x00000000,0x00000000,0x00000000
.long 0x3f943f57,0x3fae3ee2,0x3fb70000,0x00000000,0x00000000,0x00000000,0x00000000,0x00000000
.long 0x00000000,0x00000000,0x00000000,0x00000000,0x00000000,0x00000000,0x00000000,0x00000000
.long 0x3fae3ee2,0x3f57bf94,0xbf57bf94,0x00000000,0x00000000,0x00000000,0x00000000,0x00000000
.long 0x00000000,0x00000000,0x00000000,0x00000000,0x00000000,0x00000000,0x00000000,0x00000000
.long 0xbf573f94,0x3ee23fae,0x3fae3ee2,0x00000000,0x00000000,0x00000000,0x00000000,0x00000000
.long 0x00000000,0x00000000,0x00000000,0x00000000,0x00000000,0x00000000,0x00000000,0x00000000
.long 0xbf57bf94,0xbfaebee2,0xbfae3ee2,0x00000000,0x00000000,0x00000000,0x00000000,0x00000000
.long 0x00000000,0x00000000,0x00000000,0x00000000,0x00000000,0x00000000,0x00000000,0x00000000
.long 0x3faebee2,0x3f94bf57,0x3f57bf94,0x00000000,0x00000000,0x00000000,0x00000000,0x00000000
.long 0x00000000,0x00000000,0x00000000,0x00000000,0x00000000,0x00000000,0x00000000,0x00000000
.long 0xbfae3ee2,0x80003fb7,0x00000000,0x00000000,0x00000000,0x00000000,0x00000000,0x00000000
.long 0x00000000,0x00000000,0x00000000,0x00000000,0x00000000,0x00000000,0x00000000,0x00000000
.long 0x3f94bf57,0x8000bfb7,0x00000000,0x00000000,0x00000000,0x00000000,0x00000000,0x00000000
.long 0x00000000,0x00000000,0x00000000,0x00000000,0x00000000,0x00000000,0x00000000,0x00000000
.long 0xbf573f94,0x80003fb7,0x00000000,0x00000000,0x00000000,0x00000000,0x00000000,0x00000000
.long 0x00000000,0x00000000,0x00000000,0x00000000,0x00000000,0x00000000,0x00000000,0x00000000
.long 0x3ee2bfae,0x8000bfb7,0x00000000,0x00000000,0x00000000,0x00000000,0x00000000,0x00000000
.long 0x00000000,0x00000000,0x00000000,0x00000000,0x00000000,0x00000000,0x00000000,0x00000000
.long 0x00000000,0x00000000,0x00000000,0x00000000,0x80003fb7,0x3fae3ee2,0x3f57bf94,0x00000000
.long 0x00000000,0x00000000,0x00000000,0x00000000,0x00000000,0x00000000,0x00000000,0x00000000
.long 0x00000000,0x00000000,0x00000000,0x00000000,0x80003fb7,0x3f943f57,0x3faebee2,0x00000000
.long 0x00000000,0x00000000,0x00000000,0x00000000,0x00000000,0x00000000,0x00000000,0x00000000
.long 0x00000000,0x00000000,0x00000000,0x00000000,0x80003fb7,0x3f573f94,0x3fae3ee2,0x00000000
.long 0x00000000,0x00000000,0x00000000,0x00000000,0x00000000,0x00000000,0x00000000,0x00000000
.long 0x00000000,0x00000000,0x00000000,0x00000000,0x80003fb7,0x3ee23fae,0x3f573f94,0x00000000
.long 0x00000000,0x00000000,0x00000000,0x00000000,0x00000000,0x00000000,0x00000000,0x00000000
.long 0x00000000,0x00000000,0x00000000,0x00000000,0xbf57bf94,0xbfae3ee2,0x80003fb7,0x00000000
.long 0x00000000,0x00000000,0x00000000,0x00000000,0x00000000,0x00000000,0x00000000,0x00000000
.long 0x00000000,0x00000000,0x00000000,0x00000000,0x3ee2bfae,0xbf57bf94,0xbfb70000,0x00000000
.long 0x00000000,0x00000000,0x00000000,0x00000000,0x00000000,0x00000000,0x00000000,0x00000000
.long 0x00000000,0x00000000,0x00000000,0x00000000,0x3faebee2,0x3f57bf94,0x8000bfb7,0x00000000
.long 0x00000000,0x00000000,0x00000000,0x00000000,0x00000000,0x00000000,0x00000000,0x00000000
.long 0x00000000,0x00000000,0x00000000,0x00000000,0x3f943f57,0x3fae3ee2,0x3fb70000,0x00000000
.long 0x00000000,0x00000000,0x00000000,0x00000000,0x00000000,0x00000000,0x00000000,0x00000000
.long 0x00000000,0x00000000,0x00000000,0x00000000,0x3fae3ee2,0x3f57bf94,0xbf57bf94,0x00000000
.long 0x00000000,0x00000000,0x00000000,0x00000000,0x00000000,0x00000000,0x00000000,0x00000000
.long 0x00000000,0x00000000,0x00000000,0x00000000,0xbf573f94,0x3ee23fae,0x3fae3ee2,0x00000000
.long 0x00000000,0x00000000,0x00000000,0x00000000,0x00000000,0x00000000,0x00000000,0x00000000
.long 0x00000000,0x00000000,0x00000000,0x00000000,0xbf57bf94,0xbfaebee2,0xbfae3ee2,0x00000000
.long 0x00000000,0x00000000,0x00000000,0x00000000,0x00000000,0x00000000,0x00000000,0x00000000
.long 0x00000000,0x00000000,0x00000000,0x00000000,0x3faebee2,0x3f94bf57,0x3f57bf94,0x00000000
.long 0x00000000,0x00000000,0x00000000,0x00000000,0x00000000,0x00000000,0x00000000,0x00000000
.long 0x00000000,0x00000000,0x00000000,0x00000000,0xbfae3ee2,0x80003fb7,0x00000000,0x00000000
.long 0x00000000,0x00000000,0x00000000,0x00000000,0x00000000,0x00000000,0x00000000,0x00000000
.long 0x00000000,0x00000000,0x00000000,0x00000000,0x3f94bf57,0x8000bfb7,0x00000000,0x00000000
.long 0x00000000,0x00000000,0x00000000,0x00000000,0x00000000,0x00000000,0x00000000,0x00000000
.long 0x00000000,0x00000000,0x00000000,0x00000000,0xbf573f94,0x80003fb7,0x00000000,0x00000000
.long 0x00000000,0x00000000,0x00000000,0x00000000,0x00000000,0x00000000,0x00000000,0x00000000
.long 0x00000000,0x00000000,0x00000000,0x00000000,0x3ee2bfae,0x8000bfb7,0x00000000,0x00000000
.long 0x00000000,0x00000000,0x00000000,0x00000000,0x00000000,0x00000000,0x00000000,0x00000000
.long 0x00003fd0,0x00003fd0,0x00003fd0,0x00003fd0,0x00003fd0,0x3f933f93,0x3fd00000,0x3f93bf93
.long 0x00003fd0,0x3fd00000,0x0000bfd0,0xbfd00000,0x00003fd0,0x3f93bf93,0xbfd00000,0x3f933f93
.long 0x00003fd0,0x0000bfd0,0x00003fd0,0x0000bfd0,0x00003fd0,0xbf93bf93,0x3fd00000,0xbf933f93
.long 0x00003fd0,0xbfd00000,0x0000bfd0,0x3fd00000,0x00003fd0,0xbf933f93,0xbfd00000,0xbf93bf93
.long 0x00003fd0,0x00003fd0,0x00003fd0,0x00003fd0,0x00003fd0,0x3f933f93,0x3fd00000,0x3f93bf93
.long 0x00003fd0,0x3fd00000,0x0000bfd0,0xbfd00000,0x00003fd0,0x3f93bf93,0xbfd00000,0x3f933f93
.long 0x00003fd0,0x0000bfd0,0x00003fd0,0x0000bfd0,0x00003fd0,0xbf93bf93,0x3fd00000,0xbf933f93
.long 0x00003fd0,0xbfd00000,0x0000bfd0,0x3fd00000,0x00003fd0,0xbf933f93,0xbfd00000,0xbf93bf93
.long 0x00003fd0,0x00003fd0,0x00003fd0,0x00003fd0,0x0000bfd0,0xbf93bf93,0xbfd00000,0xbf933f93
.long 0x00003fd0,0x3fd00000,0x0000bfd0,0xbfd00000,0x0000bfd0,0xbf933f93,0x3fd00000,0xbf93bf93
.long 0x00003fd0,0x0000bfd0,0x00003fd0,0x0000bfd0,0x0000bfd0,0x3f933f93,0xbfd00000,0x3f93bf93
.long 0x00003fd0,0xbfd00000,0x0000bfd0,0x3fd00000,0x0000bfd0,0x3f93bf93,0x3fd00000,0x3f933f93
.long 0x00003fd0,0x00003fd0,0x00003fd0,0x00003fd0,0x0000bfd0,0xbf93bf93,0xbfd00000,0xbf933f93
.long 0x00003fd0,0x3fd00000,0x0000bfd0,0xbfd00000,0x0000bfd0,0xbf933f93,0x3fd00000,0xbf93bf93
.long 0x00003fd0,0x0000bfd0,0x00003fd0,0x0000bfd0,0x0000bfd0,0x3f933f93,0xbfd00000,0x3f93bf93
.long 0x00003fd0,0xbfd00000,0x0000bfd0,0x3fd00000,0x0000bfd0,0x3f93bf93,0x3fd00000,0x3f933f93
.long 0x00003fd0,0x00003fd0,0x00003fd0,0x00003fd0,0xbf1f3fc0,0xbfc03f1f,0xbfc0bf1f,0xbf1fbfc0
.long 0xbf933f93,0xbf93bf93,0x3f93bf93,0x3f933f93,0xbfc03f1f,0x3f1fbfc0,0x3f1f3fc0,0xbfc0bf1f
.long 0xbfd00000,0x3fd00000,0xbfd00000,0x3fd00000,0xbfc0bf1f,0x3f1f3fc0,0x3f1fbfc0,0xbfc03f1f
.long 0xbf93bf93,0xbf933f93,0x3f933f93,0x3f93bf93,0xbf1fbfc0,0xbfc0bf1f,0xbfc03f1f,0xbf1f3fc0
.long 0x0000bfd0,0x0000bfd0,0x0000bfd0,0x0000bfd0,0x3f1fbfc0,0x3fc0bf1f,0x3fc03f1f,0x3f1f3fc0
.long 0x3f93bf93,0x3f933f93,0xbf933f93,0xbf93bf93,0x3fc0bf1f,0xbf1f3fc0,0xbf1fbfc0,0x3fc03f1f
.long 0x3fd00000,0xbfd00000,0x3fd00000,0xbfd00000,0x3fc03f1f,0xbf1fbfc0,0xbf1f3fc0,0x3fc0bf1f
.long 0x3f933f93,0x3f93bf93,0xbf93bf93,0xbf933f93,0x3f1f3fc0,0x3fc03f1f,0x3fc0bf1f,0x3f1fbfc0
.long 0x00003fd0,0x00003fd0,0x00003fd0,0x00003fd0,0x3f1fbfc0,0x3fc0bf1f,0x3fc03f1f,0x3f1f3fc0
.long 0xbf933f93,0xbf93bf93,0x3f93bf93,0x3f933f93,0x3fc0bf1f,0xbf1f3fc0,0xbf1fbfc0,0x3fc03f1f
.long 0xbfd00000,0x3fd00000,0xbfd00000,0x3fd00000,0x3fc03f1f,0xbf1fbfc0,0xbf1f3fc0,0x3fc0bf1f
.long 0xbf93bf93,0xbf933f93,0x3f933f93,0x3f93bf93,0x3f1f3fc0,0x3fc03f1f,0x3fc0bf1f,0x3f1fbfc0
.long 0x0000bfd0,0x0000bfd0,0x0000bfd0,0x0000bfd0,0xbf1f3fc0,0xbfc03f1f,0xbfc0bf1f,0xbf1fbfc0
.long 0x3f93bf93,0x3f933f93,0xbf933f93,0xbf93bf93,0xbfc03f1f,0x3f1fbfc0,0x3f1f3fc0,0xbfc0bf1f
.long 0x3fd00000,0xbfd00000,0x3fd00000,0xbfd00000,0xbfc0bf1f,0x3f1f3fc0,0x3f1fbfc0,0xbfc03f1f
.long 0x3f933f93,0x3f93bf93,0xbf93bf93,0xbf933f93,0xbf1fbfc0,0xbfc0bf1f,0xbfc03f1f,0xbf1f3fc0
.long 0x00003fd0,0x00003fd0,0x00003fd0,0x00003fd0,0x3f1f3fc0,0x3fc03f1f,0x3fc0bf1f,0x3f1fbfc0
.long 0x3f933f93,0x3f93bf93,0xbf93bf93,0xbf933f93,0x3fc03f1f,0xbf1fbfc0,0xbf1f3fc0,0x3fc0bf1f
.long 0x3fd00000,0xbfd00000,0x3fd00000,0xbfd00000,0x3fc0bf1f,0xbf1f3fc0,0xbf1fbfc0,0x3fc03f1f
.long 0x3f93bf93,0x3f933f93,0xbf933f93,0xbf93bf93,0x3f1fbfc0,0x3fc0bf1f,0x3fc03f1f,0x3f1f3fc0
.long 0x0000bfd0,0x0000bfd0,0x0000bfd0,0x0000bfd0,0xbf1fbfc0,0xbfc0bf1f,0xbfc03f1f,0xbf1f3fc0
.long 0xbf93bf93,0xbf933f93,0x3f933f93,0x3f93bf93,0xbfc0bf1f,0x3f1f3fc0,0x3f1fbfc0,0xbfc03f1f
.long 0xbfd00000,0x3fd00000,0xbfd00000,0x3fd00000,0xbfc03f1f,0x3f1fbfc0,0x3f1f3fc0,0xbfc0bf1f
.long 0xbf933f93,0xbf93bf93,0x3f93bf93,0x3f933f93,0xbf1f3fc0,0xbfc03f1f,0xbfc0bf1f,0xbf1fbfc0
.long 0x00003fd0,0x00003fd0,0x00003fd0,0x00003fd0,0xbf1fbfc0,0xbfc0bf1f,0xbfc03f1f,0xbf1f3fc0
.long 0x3f933f93,0x3f93bf93,0xbf93bf93,0xbf933f93,0xbfc0bf1f,0x3f1f3fc0,0x3f1fbfc0,0xbfc03f1f
.long 0x3fd00000,0xbfd00000,0x3fd00000,0xbfd00000,0xbfc03f1f,0x3f1fbfc0,0x3f1f3fc0,0xbfc0bf1f
.long 0x3f93bf93,0x3f933f93,0xbf933f93,0xbf93bf93,0xbf1f3fc0,0xbfc03f1f,0xbfc0bf1f,0xbf1fbfc0
.long 0x0000bfd0,0x0000bfd0,0x0000bfd0,0x0000bfd0,0x3f1f3fc0,0x3fc03f1f,0x3fc0bf1f,0x3f1fbfc0
.long 0xbf93bf93,0xbf933f93,0x3f933f93,0x3f93bf93,0x3fc03f1f,0xbf1fbfc0,0xbf1f3fc0,0x3fc0bf1f
.long 0xbfd00000,0x3fd00000,0xbfd00000,0x3fd00000,0x3fc0bf1f,0xbf1f3fc0,0xbf1fbfc0,0x3fc03f1f
.long 0xbf933f93,0xbf93bf93,0x3f93bf93,0x3f933f93,0x3f1fbfc0,0x3fc0bf1f,0x3fc03f1f,0x3f1f3fc0
.long 0x00003fd0,0x00003fd0,0x00003fd0,0x00003fd0,0xbf933f93,0xbfd00000,0xbf93bf93,0x0000bfd0
.long 0xbfd00000,0x0000bfd0,0x3fd00000,0x00003fd0,0xbf93bf93,0x3fd00000,0xbf933f93,0x0000bfd0
.long 0x0000bfd0,0x00003fd0,0x0000bfd0,0x00003fd0,0x3f93bf93,0xbfd00000,0x3f933f93,0x0000bfd0
.long 0x3fd00000,0x0000bfd0,0xbfd00000,0x00003fd0,0x3f933f93,0x3fd00000,0x3f93bf93,0x0000bfd0
.long 0x00003fd0,0x00003fd0,0x00003fd0,0x00003fd0,0xbf933f93,0xbfd00000,0xbf93bf93,0x0000bfd0
.long 0xbfd00000,0x0000bfd0,0x3fd00000,0x00003fd0,0xbf93bf93,0x3fd00000,0xbf933f93,0x0000bfd0
.long 0x0000bfd0,0x00003fd0,0x0000bfd0,0x00003fd0,0x3f93bf93,0xbfd00000,0x3f933f93,0x0000bfd0
.long 0x3fd00000,0x0000bfd0,0xbfd00000,0x00003fd0,0x3f933f93,0x3fd00000,0x3f93bf93,0x0000bfd0
.long 0x00003fd0,0x00003fd0,0x00003fd0,0x00003fd0,0x3f93bf93,0x3fd00000,0x3f933f93,0x00003fd0
.long 0xbfd00000,0x0000bfd0,0x3fd00000,0x00003fd0,0x3f933f93,0xbfd00000,0x3f93bf93,0x00003fd0
.long 0x0000bfd0,0x00003fd0,0x0000bfd0,0x00003fd0,0xbf933f93,0x3fd00000,0xbf93bf93,0x00003fd0
.long 0x3fd00000,0x0000bfd0,0xbfd00000,0x00003fd0,0xbf93bf93,0xbfd00000,0xbf933f93,0x00003fd0
.long 0x00003fd0,0x00003fd0,0x00003fd0,0x00003fd0,0x3f93bf93,0x3fd00000,0x3f933f93,0x00003fd0
.long 0xbfd00000,0x0000bfd0,0x3fd00000,0x00003fd0,0x3f933f93,0xbfd00000,0x3f93bf93,0x00003fd0
.long 0x0000bfd0,0x00003fd0,0x0000bfd0,0x00003fd0,0xbf933f93,0x3fd00000,0xbf93bf93,0x00003fd0
.long 0x3fd00000,0x0000bfd0,0xbfd00000,0x00003fd0,0xbf93bf93,0xbfd00000,0xbf933f93,0x00003fd0
.long 0x00003fd0,0x3f1f3fc0,0x3f933f93,0x3fc03f1f,0x00003fd0,0x3fc03f1f,0x3f93bf93,0xbf1fbfc0
.long 0x00003fd0,0x3fc0bf1f,0xbf93bf93,0xbf1f3fc0,0x00003fd0,0x3f1fbfc0,0xbf933f93,0x3fc0bf1f
.long 0x00003fd0,0xbf1fbfc0,0x3f933f93,0xbfc0bf1f,0x00003fd0,0xbfc0bf1f,0x3f93bf93,0x3f1f3fc0
.long 0x00003fd0,0xbfc03f1f,0xbf93bf93,0x3f1fbfc0,0x00003fd0,0xbf1f3fc0,0xbf933f93,0xbfc03f1f
.long 0x00003fd0,0x3f1f3fc0,0x3f933f93,0x3fc03f1f,0x00003fd0,0x3fc03f1f,0x3f93bf93,0xbf1fbfc0
.long 0x00003fd0,0x3fc0bf1f,0xbf93bf93,0xbf1f3fc0,0x00003fd0,0x3f1fbfc0,0xbf933f93,0x3fc0bf1f
.long 0x00003fd0,0xbf1fbfc0,0x3f933f93,0xbfc0bf1f,0x00003fd0,0xbfc0bf1f,0x3f93bf93,0x3f1f3fc0
.long 0x00003fd0,0xbfc03f1f,0xbf93bf93,0x3f1fbfc0,0x00003fd0,0xbf1f3fc0,0xbf933f93,0xbfc03f1f
.long 0x3fd00000,0x3fc0bf1f,0x3f93bf93,0x3f1fbfc0,0xbfd00000,0xbf1f3fc0,0x3f933f93,0x3fc0bf1f
.long 0x3fd00000,0xbf1fbfc0,0xbf933f93,0x3fc03f1f,0xbfd00000,0x3fc03f1f,0xbf93bf93,0x3f1f3fc0
.long 0x3fd00000,0xbfc03f1f,0x3f93bf93,0xbf1f3fc0,0xbfd00000,0x3f1fbfc0,0x3f933f93,0xbfc03f1f
.long 0x3fd00000,0x3f1f3fc0,0xbf933f93,0xbfc0bf1f,0xbfd00000,0xbfc0bf1f,0xbf93bf93,0xbf1fbfc0
.long 0x3fd00000,0x3fc0bf1f,0x3f93bf93,0x3f1fbfc0,0xbfd00000,0xbf1f3fc0,0x3f933f93,0x3fc0bf1f
.long 0x3fd00000,0xbf1fbfc0,0xbf933f93,0x3fc03f1f,0xbfd00000,0x3fc03f1f,0xbf93bf93,0x3f1f3fc0
.long 0x3fd00000,0xbfc03f1f,0x3f93bf93,0xbf1f3fc0,0xbfd00000,0x3f1fbfc0,0x3f933f93,0xbfc03f1f
.long 0x3fd00000,0x3f1f3fc0,0xbf933f93,0xbfc0bf1f,0xbfd00000,0xbfc0bf1f,0xbf93bf93,0xbf1fbfc0
.long 0xbea23fcc,0xbf673fad,0xbfad3f67,0xbfcc3ea2,0xbf673fad,0xbfccbea2,0xbea2bfcc,0x3fadbf67
.long 0xbfad3f67,0xbea2bfcc,0x3fcc3ea2,0xbf673fad,0xbfcc3ea2,0x3fadbf67,0xbf673fad,0x3ea2bfcc
.long 0xbfccbea2,0x3fad3f67,0xbf67bfad,0x3ea23fcc,0xbfadbf67,0xbea23fcc,0x3fccbea2,0xbf67bfad
.long 0xbf67bfad,0xbfcc3ea2,0xbea23fcc,0x3fad3f67,0xbea2bfcc,0xbf67bfad,0xbfadbf67,0xbfccbea2
.long 0x3ea2bfcc,0x3f67bfad,0x3fadbf67,0x3fccbea2,0x3f67bfad,0x3fcc3ea2,0x3ea23fcc,0xbfad3f67
.long 0x3fadbf67,0x3ea23fcc,0xbfccbea2,0x3f67bfad,0x3fccbea2,0xbfad3f67,0x3f67bfad,0xbea23fcc
.long 0x3fcc3ea2,0xbfadbf67,0x3f673fad,0xbea2bfcc,0x3fad3f67,0x3ea2bfcc,0xbfcc3ea2,0x3f673fad
.long 0x3f673fad,0x3fccbea2,0x3ea2bfcc,0xbfadbf67,0x3ea23fcc,0x3f673fad,0x3fad3f67,0x3fcc3ea2
.long 0xbfccbea2,0xbfadbf67,0xbf67bfad,0xbea2bfcc,0x3fad3f67,0xbea23fcc,0xbfcc3ea2,0xbf67bfad
.long 0xbf67bfad,0x3fccbea2,0xbea23fcc,0xbfadbf67,0x3ea23fcc,0xbf67bfad,0x3fad3f67,0xbfccbea2
.long 0x3ea2bfcc,0xbf673fad,0x3fadbf67,0xbfcc3ea2,0xbf673fad,0x3fcc3ea2,0xbea2bfcc,0xbfad3f67
.long 0x3fadbf67,0xbea2bfcc,0xbfccbea2,0xbf673fad,0xbfcc3ea2,0xbfad3f67,0xbf673fad,0xbea23fcc
.long 0x3fcc3ea2,0x3fad3f67,0x3f673fad,0x3ea23fcc,0xbfadbf67,0x3ea2bfcc,0x3fccbea2,0x3f673fad
.long 0x3f673fad,0xbfcc3ea2,0x3ea2bfcc,0x3fad3f67,0xbea2bfcc,0x3f673fad,0xbfadbf67,0x3fcc3ea2
.long 0xbea23fcc,0x3f67bfad,0xbfad3f67,0x3fccbea2,0x3f67bfad,0xbfccbea2,0x3ea23fcc,0x3fadbf67
.long 0xbfad3f67,0x3ea23fcc,0x3fcc3ea2,0x3f67bfad,0x3fccbea2,0x3fadbf67,0x3f67bfad,0x3ea2bfcc
.long 0x3ea23fcc,0x3f673fad,0x3fad3f67,0x3fcc3ea2,0x3f673fad,0x3fccbea2,0x3ea2bfcc,0xbfadbf67
.long 0x3fad3f67,0x3ea2bfcc,0xbfcc3ea2,0x3f673fad,0x3fcc3ea2,0xbfadbf67,0x3f673fad,0xbea2bfcc
.long 0x3fccbea2,0xbfad3f67,0x3f67bfad,0xbea23fcc,0x3fadbf67,0x3ea23fcc,0xbfccbea2,0x3f67bfad
.long 0x3f67bfad,0x3fcc3ea2,0x3ea23fcc,0xbfad3f67,0x3ea2bfcc,0x3f67bfad,0x3fadbf67,0x3fccbea2
.long 0xbea2bfcc,0xbf67bfad,0xbfadbf67,0xbfccbea2,0xbf67bfad,0xbfcc3ea2,0xbea23fcc,0x3fad3f67
.long 0xbfadbf67,0xbea23fcc,0x3fccbea2,0xbf67bfad,0xbfccbea2,0x3fad3f67,0xbf67bfad,0x3ea23fcc
.long 0xbfcc3ea2,0x3fadbf67,0xbf673fad,0x3ea2bfcc,0xbfad3f67,0xbea2bfcc,0x3fcc3ea2,0xbf673fad
.long 0xbf673fad,0xbfccbea2,0xbea2bfcc,0x3fadbf67,0xbea23fcc,0xbf673fad,0xbfad3f67,0xbfcc3ea2
.long 0x3fccbea2,0x3fadbf67,0x3f67bfad,0x3ea2bfcc,0xbfad3f67,0x3ea23fcc,0x3fcc3ea2,0x3f67bfad
.long 0x3f67bfad,0xbfccbea2,0x3ea23fcc,0x3fadbf67,0xbea23fcc,0x3f67bfad,0xbfad3f67,0x3fccbea2
.long 0xbea2bfcc,0x3f673fad,0xbfadbf67,0x3fcc3ea2,0x3f673fad,0xbfcc3ea2,0x3ea2bfcc,0x3fad3f67
.long 0xbfadbf67,0x3ea2bfcc,0x3fccbea2,0x3f673fad,0x3fcc3ea2,0x3fad3f67,0x3f673fad,0x3ea23fcc
.long 0xbfcc3ea2,0xbfad3f67,0xbf673fad,0xbea23fcc,0x3fadbf67,0xbea2bfcc,0xbfccbea2,0xbf673fad
.long 0xbf673fad,0x3fcc3ea2,0xbea2bfcc,0xbfad3f67,0x3ea2bfcc,0xbf673fad,0x3fadbf67,0xbfcc3ea2
.long 0x3ea23fcc,0xbf67bfad,0x3fad3f67,0xbfccbea2,0xbf67bfad,0x3fccbea2,0xbea23fcc,0xbfadbf67
.long 0x3fad3f67,0xbea23fcc,0xbfcc3ea2,0xbf67bfad,0xbfccbea2,0xbfadbf67,0xbf67bfad,0xbea2bfcc
.long 0xbf1f3fc0,0xbf933f93,0xbfc03f1f,0xbfd00000,0xbfc03f1f,0xbf93bf93,0x3f1fbfc0,0x3fd00000
.long 0xbfc0bf1f,0x3f93bf93,0x3f1f3fc0,0xbfd00000,0xbf1fbfc0,0x3f933f93,0xbfc0bf1f,0x3fd00000
.long 0x3f1fbfc0,0xbf933f93,0x3fc0bf1f,0xbfd00000,0x3fc0bf1f,0xbf93bf93,0xbf1f3fc0,0x3fd00000
.long 0x3fc03f1f,0x3f93bf93,0xbf1fbfc0,0xbfd00000,0x3f1f3fc0,0x3f933f93,0x3fc03f1f,0x3fd00000
.long 0xbf1f3fc0,0xbf933f93,0xbfc03f1f,0xbfd00000,0xbfc03f1f,0xbf93bf93,0x3f1fbfc0,0x3fd00000
.long 0xbfc0bf1f,0x3f93bf93,0x3f1f3fc0,0xbfd00000,0xbf1fbfc0,0x3f933f93,0xbfc0bf1f,0x3fd00000
.long 0x3f1fbfc0,0xbf933f93,0x3fc0bf1f,0xbfd00000,0x3fc0bf1f,0xbf93bf93,0xbf1f3fc0,0x3fd00000
.long 0x3fc03f1f,0x3f93bf93,0xbf1fbfc0,0xbfd00000,0x3f1f3fc0,0x3f933f93,0x3fc03f1f,0x3fd00000
.long 0xbfc0bf1f,0xbf93bf93,0xbf1fbfc0,0x0000bfd0,0x3f1f3fc0,0xbf933f93,0xbfc0bf1f,0x0000bfd0
.long 0x3f1fbfc0,0x3f933f93,0xbfc03f1f,0x0000bfd0,0xbfc03f1f,0x3f93bf93,0xbf1f3fc0,0x0000bfd0
.long 0x3fc03f1f,0xbf93bf93,0x3f1f3fc0,0x0000bfd0,0xbf1fbfc0,0xbf933f93,0x3fc03f1f,0x0000bfd0
.long 0xbf1f3fc0,0x3f933f93,0x3fc0bf1f,0x0000bfd0,0x3fc0bf1f,0x3f93bf93,0x3f1fbfc0,0x0000bfd0
.long 0xbfc0bf1f,0xbf93bf93,0xbf1fbfc0,0x0000bfd0,0x3f1f3fc0,0xbf933f93,0xbfc0bf1f,0x0000bfd0
.long 0x3f1fbfc0,0x3f933f93,0xbfc03f1f,0x0000bfd0,0xbfc03f1f,0x3f93bf93,0xbf1f3fc0,0x0000bfd0
.long 0x3fc03f1f,0xbf93bf93,0x3f1f3fc0,0x0000bfd0,0xbf1fbfc0,0xbf933f93,0x3fc03f1f,0x0000bfd0
.long 0xbf1f3fc0,0x3f933f93,0x3fc0bf1f,0x0000bfd0,0x3fc0bf1f,0x3f93bf93,0x3f1fbfc0,0x0000bfd0
.long 0x00003f91,0x00003f91,0x00003f91,0x00003f91,0x00003f91,0x3ede3f86,0x3f4d3f4d,0x3f863ede
.long 0x00003f91,0x3f4d3f4d,0x3f910000,0x3f4dbf4d,0x00003f91,0x3f863ede,0x3f4dbf4d,0xbedebf86
.long 0x00003f91,0x3f910000,0x0000bf91,0xbf910000,0x00003f91,0x3f86bede,0xbf4dbf4d,0xbede3f86
.long 0x00003f91,0x3f4dbf4d,0xbf910000,0x3f4d3f4d,0x00003f91,0x3edebf86,0xbf4d3f4d,0x3f86bede
.long 0x00003f91,0x0000bf91,0x00003f91,0x0000bf91,0x00003f91,0xbedebf86,0x3f4d3f4d,0xbf86bede
.long 0x00003f91,0xbf4dbf4d,0x3f910000,0xbf4d3f4d,0x00003f91,0xbf86bede,0x3f4dbf4d,0x3ede3f86
.long 0x00003f91,0xbf910000,0x0000bf91,0x3f910000,0x00003f91,0xbf863ede,0xbf4dbf4d,0x3edebf86
.long 0x00003f91,0xbf4d3f4d,0xbf910000,0xbf4dbf4d,0x00003f91,0xbede3f86,0xbf4d3f4d,0xbf863ede
.long 0x00003f91,0x00003f91,0x00003f91,0x00003f91,0x3f910000,0x3f86bede,0x3f4dbf4d,0x3edebf86
.long 0x0000bf91,0xbf4dbf4d,0xbf910000,0xbf4d3f4d,0xbf910000,0xbede3f86,0x3f4d3f4d,0x3f86bede
.long 0x00003f91,0x3f910000,0x0000bf91,0xbf910000,0x3f910000,0xbedebf86,0xbf4d3f4d,0x3f863ede
.long 0x0000bf91,0xbf4d3f4d,0x3f910000,0xbf4dbf4d,0xbf910000,0x3f863ede,0xbf4dbf4d,0x3ede3f86
.long 0x00003f91,0x0000bf91,0x00003f91,0x0000bf91,0x3f910000,0xbf863ede,0x3f4dbf4d,0xbede3f86
.long 0x0000bf91,0x3f4d3f4d,0xbf910000,0x3f4dbf4d,0xbf910000,0x3edebf86,0x3f4d3f4d,0xbf863ede
.long 0x00003f91,0xbf910000,0x0000bf91,0x3f910000,0x3f910000,0x3ede3f86,0xbf4d3f4d,0xbf86bede
.long 0x0000bf91,0x3f4dbf4d,0x3f910000,0x3f4d3f4d,0xbf910000,0xbf86bede,0xbf4dbf4d,0xbedebf86
.long 0x00003f91,0x00003f91,0x00003f91,0x00003f91,0x0000bf91,0xbedebf86,0xbf4dbf4d,0xbf86bede
.long 0x00003f91,0x3f4d3f4d,0x3f910000,0x3f4dbf4d,0x0000bf91,0xbf86bede,0xbf4d3f4d,0x3ede3f86
.long 0x00003f91,0x3f910000,0x0000bf91,0xbf910000,0x0000bf91,0xbf863ede,0x3f4d3f4d,0x3edebf86
.long 0x00003f91,0x3f4dbf4d,0xbf910000,0x3f4d3f4d,0x0000bf91,0xbede3f86,0x3f4dbf4d,0xbf863ede
.long 0x00003f91,0x0000bf91,0x00003f91,0x0000bf91,0x0000bf91,0x3ede3f86,0xbf4dbf4d,0x3f863ede
.long 0x00003f91,0xbf4dbf4d,0x3f910000,0xbf4d3f4d,0x0000bf91,0x3f863ede,0xbf4d3f4d,0xbedebf86
.long 0x00003f91,0xbf910000,0x0000bf91,0x3f910000,0x0000bf91,0x3f86bede,0x3f4d3f4d,0xbede3f86
.long 0x00003f91,0xbf4d3f4d,0xbf910000,0xbf4dbf4d,0x0000bf91,0x3edebf86,0x3f4dbf4d,0x3f86bede
.long 0x00003f91,0x00003f91,0x00003f91,0x00003f91,0xbf910000,0xbf863ede,0xbf4d3f4d,0xbede3f86
.long 0x0000bf91,0xbf4dbf4d,0xbf910000,0xbf4d3f4d,0x3f910000,0x3edebf86,0xbf4dbf4d,0xbf863ede
.long 0x00003f91,0x3f910000,0x0000bf91,0xbf910000,0xbf910000,0x3ede3f86,0x3f4dbf4d,0xbf86bede
.long 0x0000bf91,0xbf4d3f4d,0x3f910000,0xbf4dbf4d,0x3f910000,0xbf86bede,0x3f4d3f4d,0xbedebf86
.long 0x00003f91,0x0000bf91,0x00003f91,0x0000bf91,0xbf910000,0x3f86bede,0xbf4d3f4d,0x3edebf86
.long 0x0000bf91,0x3f4d3f4d,0xbf910000,0x3f4dbf4d,0x3f910000,0xbede3f86,0xbf4dbf4d,0x3f86bede
.long 0x00003f91,0xbf910000,0x0000bf91,0x3f910000,0xbf910000,0xbedebf86,0x3f4dbf4d,0x3f863ede
.long 0x0000bf91,0x3f4dbf4d,0x3f910000,0x3f4d3f4d,0x3f910000,0x3f863ede,0x3f4d3f4d,0x3ede3f86
.long 0x3f918000,0x3f918000,0x3f918000,0x3f918000,0x3f918000,0x3f86bede,0x3f4dbf4d,0x3edebf86
.long 0x3f918000,0x3f4dbf4d,0x0000bf91,0xbf4dbf4d,0x3f918000,0x3edebf86,0xbf4dbf4d,0xbf863ede
.long 0x3f918000,0x0000bf91,0xbf918000,0x00003f91,0x3f918000,0xbedebf86,0xbf4d3f4d,0x3f863ede
.long 0x3f918000,0xbf4dbf4d,0x00003f91,0x3f4dbf4d,0x3f918000,0xbf86bede,0x3f4d3f4d,0xbedebf86
.long 0x3f918000,0xbf918000,0x3f918000,0xbf918000,0x3f918000,0xbf863ede,0x3f4dbf4d,0xbede3f86
.long 0x3f918000,0xbf4d3f4d,0x0000bf91,0x3f4d3f4d,0x3f918000,0xbede3f86,0xbf4dbf4d,0x3f86bede
.long 0x3f918000,0x00003f91,0xbf918000,0x0000bf91,0x3f918000,0x3ede3f86,0xbf4d3f4d,0xbf86bede
.long 0x3f918000,0x3f4d3f4d,0x00003f91,0xbf4d3f4d,0x3f918000,0x3f863ede,0x3f4d3f4d,0x3ede3f86
.long 0x3f918000,0x3f918000,0x3f918000,0x3f918000,0x0000bf91,0xbedebf86,0xbf4dbf4d,0xbf86bede
.long 0xbf918000,0xbf4d3f4d,0x00003f91,0x3f4d3f4d,0x00003f91,0x3f863ede,0x3f4dbf4d,0xbedebf86
.long 0x3f918000,0x0000bf91,0xbf918000,0x00003f91,0x0000bf91,0xbf863ede,0x3f4d3f4d,0x3edebf86
.long 0xbf918000,0x3f4d3f4d,0x0000bf91,0xbf4d3f4d,0x00003f91,0x3edebf86,0xbf4d3f4d,0x3f86bede
.long 0x3f918000,0xbf918000,0x3f918000,0xbf918000,0x0000bf91,0x3ede3f86,0xbf4dbf4d,0x3f863ede
.long 0xbf918000,0x3f4dbf4d,0x00003f91,0xbf4dbf4d,0x00003f91,0xbf86bede,0x3f4dbf4d,0x3ede3f86
.long 0x3f918000,0x00003f91,0xbf918000,0x0000bf91,0x0000bf91,0x3f86bede,0x3f4d3f4d,0xbede3f86
.long 0xbf918000,0xbf4dbf4d,0x0000bf91,0x3f4dbf4d,0x00003f91,0xbede3f86,0xbf4d3f4d,0xbf863ede
.long 0x3f918000,0x3f918000,0x3f918000,0x3f918000,0xbf918000,0xbf863ede,0xbf4d3f4d,0xbede3f86
.long 0x3f918000,0x3f4dbf4d,0x0000bf91,0xbf4dbf4d,0xbf918000,0xbede3f86,0x3f4d3f4d,0x3f86bede
.long 0x3f918000,0x0000bf91,0xbf918000,0x00003f91,0xbf918000,0x3ede3f86,0x3f4dbf4d,0xbf86bede
.long 0x3f918000,0xbf4dbf4d,0x00003f91,0x3f4dbf4d,0xbf918000,0x3f863ede,0xbf4dbf4d,0x3ede3f86
.long 0x3f918000,0xbf918000,0x3f918000,0xbf918000,0xbf918000,0x3f86bede,0xbf4d3f4d,0x3edebf86
.long 0x3f918000,0xbf4d3f4d,0x0000bf91,0x3f4d3f4d,0xbf918000,0x3edebf86,0x3f4d3f4d,0xbf863ede
.long 0x3f918000,0x00003f91,0xbf918000,0x0000bf91,0xbf918000,0xbedebf86,0x3f4dbf4d,0x3f863ede
.long 0x3f918000,0x3f4d3f4d,0x00003f91,0xbf4d3f4d,0xbf918000,0xbf86bede,0xbf4dbf4d,0xbedebf86
.long 0x3f918000,0x3f918000,0x3f918000,0x3f918000,0x00003f91,0x3ede3f86,0x3f4d3f4d,0x3f863ede
.long 0xbf918000,0xbf4d3f4d,0x00003f91,0x3f4d3f4d,0x0000bf91,0xbf86bede,0xbf4d3f4d,0x3ede3f86
.long 0x3f918000,0x0000bf91,0xbf918000,0x00003f91,0x00003f91,0x3f86bede,0xbf4dbf4d,0xbede3f86
.long 0xbf918000,0x3f4d3f4d,0x0000bf91,0xbf4d3f4d,0x0000bf91,0xbede3f86,0x3f4dbf4d,0xbf863ede
.long 0x3f918000,0xbf918000,0x3f918000,0xbf918000,0x00003f91,0xbedebf86,0x3f4d3f4d,0xbf86bede
.long 0xbf918000,0x3f4dbf4d,0x00003f91,0xbf4dbf4d,0x0000bf91,0x3f863ede,0xbf4d3f4d,0xbedebf86
.long 0x3f918000,0x00003f91,0xbf918000,0x0000bf91,0x00003f91,0xbf863ede,0xbf4dbf4d,0x3edebf86
.long 0xbf918000,0xbf4dbf4d,0x0000bf91,0x3f4dbf4d,0x0000bf91,0x3edebf86,0x3f4dbf4d,0x3f86bede
.long 0x3f800000,0x3f800000,0x3f800000,0x3f800000,0x3f800000,0x3f7fec43,0x3f7fb10f,0x3f7f4e6d
.long 0x3f800000,0x3f7fb10f,0x3f7ec46d,0x3f7d3aac,0x3f800000,0x3f7f4e6d,0x3f7d3aac,0x3f79c79d
.long 0x3f800000,0x3f7ec46d,0x3f7b14be,0x3f74fa0b,0x3f800000,0x3f7e1324,0x3f7853f8,0x3f6ed89e
.long 0x3f800000,0x3f7d3aac,0x3f74fa0b,0x3f676bd8,0x3f800000,0x3f7c3b28,0x3f710908,0x3f5ebe05
.long 0x3f800000,0x3f7b14be,0x3f6c835e,0x3f54db31,0x3f800000,0x3f79c79d,0x3f676bd8,0x3f49d112
.long 0x3f800000,0x3f7853f8,0x3f61c598,0x3f3daef9,0x3f800000,0x3f76ba07,0x3f5b941a,0x3f3085bb
.long 0x3f800000,0x3f74fa0b,0x3f54db31,0x3f226799,0x3f800000,0x3f731447,0x3f4d9f02,0x3f13682a
.long 0x3f800000,0x3f710908,0x3f45e403,0x3f039c3d,0x3f800000,0x3f6ed89e,0x3f3daef9,0x3ee63375
.long 0x3f800000,0x3f800000,0x3f800000,0x3f800000,0x3f7ec46d,0x3f7e1324,0x3f7d3aac,0x3f7c3b28
.long 0x3f7b14be,0x3f7853f8,0x3f74fa0b,0x3f710908,0x3f74fa0b,0x3f6ed89e,0x3f676bd8,0x3f5ebe05
.long 0x3f6c835e,0x3f61c598,0x3f54db31,0x3f45e403,0x3f61c598,0x3f514d3d,0x3f3daef9,0x3f273656
.long 0x3f54db31,0x3f3daef9,0x3f226799,0x3f039c3d,0x3f45e403,0x3f273656,0x3f039c3d,0x3eb8442a
.long 0x3f3504f3,0x3f0e39da,0x3ec3ef15,0x3e47c5c2,0x3f226799,0x3ee63375,0x3e78cfcc,0x3cc90ab0
.long 0x3f0e39da,0x3eac7cd4,0x3dc8bd36,0xbe164083,0x3ef15aea,0x3e605c13,0xbd48fb30,0xbea09ae5
.long 0x3ec3ef15,0x3dc8bd36,0xbe47c5c2,0xbef15aea,0x3e94a031,0xbcc90ab0,0xbeac7cd4,0xbf1d7fd1
.long 0x3e47c5c2,0xbe164083,0xbef15aea,0xbf3daef9,0x3dc8bd36,0xbe888e93,0xbf187fc0,0xbf584853
.long 0x3f800000,0x3f800000,0x3f800000,0x3f800000,0x3f7b14be,0x3f79c79d,0x3f7853f8,0x3f76ba07
.long 0x3f6c835e,0x3f676bd8,0x3f61c598,0x3f5b941a,0x3f54db31,0x3f49d112,0x3f3daef9,0x3f3085bb
.long 0x3f3504f3,0x3f226799,0x3f0e39da,0x3ef15aea,0x3f0e39da,0x3ee63375,0x3eac7cd4,0x3e605c13
.long 0x3ec3ef15,0x3e78cfcc,0x3dc8bd36,0xbd48fb30,0x3e47c5c2,0x3cc90ab0,0xbe164083,0xbea09ae5
.long 0x00000000,0xbe47c5c2,0xbec3ef15,0xbf0e39da,0xbe47c5c2,0xbecf7bca,0xbf187fc0,0xbf41d870
.long 0xbec3ef15,0xbf187fc0,0xbf45e403,0xbf676bd8,0xbf0e39da,0xbf41d870,0xbf676bd8,0xbf7c3b28
.long 0xbf3504f3,0xbf61c598,0xbf7b14be,0xbf7ec46d,0xbf54db31,0xbf76ba07,0xbf7fb10f,0xbf6ed89e
.long 0xbf6c835e,0xbf7fb10f,0xbf74fa0b,0xbf4d9f02,0xbf7b14be,0xbf7c3b28,0xbf5b941a,0xbf1d7fd1
.long 0x3f800000,0x3f800000,0x3f800000,0x3f800000,0x3f74fa0b,0x3f731447,0x3f710908,0x3f6ed89e
.long 0x3f54db31,0x3f4d9f02,0x3f45e403,0x3f3daef9,0x3f226799,0x3f13682a,0x3f039c3d,0x3ee63375
.long 0x3ec3ef15,0x3e94a031,0x3e47c5c2,0x3dc8bd36,0x3dc8bd36,0xbcc90ab0,0xbe164083,0xbe888e93
.long 0xbe47c5c2,0xbeac7cd4,0xbef15aea,0xbf187fc0,0xbef15aea,0xbf1d7fd1,0xbf3daef9,0xbf584853
.long 0xbf3504f3,0xbf54db31,0xbf6c835e,0xbf7b14be,0xbf61c598,0xbf76ba07,0xbf7fb10f,0xbf7c3b28
.long 0xbf7b14be,0xbf7fb10f,0xbf74fa0b,0xbf5b941a,0xbf7ec46d,0xbf6ed89e,0xbf4d9f02,0xbf1d7fd1
.long 0xbf6c835e,0xbf45e403,0xbf0e39da,0xbe94a031,0xbf45e403,0xbf08f59b,0xbe78cfcc,0x3d96a905
.long 0xbf0e39da,0xbe78cfcc,0x3dc8bd36,0x3edae880,0xbe94a031,0x3d96a905,0x3edae880,0x3f396842
.long 0x00000000,0x00000000,0x00000000,0x00000000,0x00000000,0x3cc90ab0,0x3d48fb30,0x3d96a905
.long 0x00000000,0x3d48fb30,0x3dc8bd36,0x3e164083,0x00000000,0x3d96a905,0x3e164083,0x3e605c13
.long 0x00000000,0x3dc8bd36,0x3e47c5c2,0x3e94a031,0x00000000,0x3dfab273,0x3e78cfcc,0x3eb8442a
.long 0x00000000,0x3e164083,0x3e94a031,0x3edae880,0x00000000,0x3e2f10a2,0x3eac7cd4,0x3efc5d27
.long 0x00000000,0x3e47c5c2,0x3ec3ef15,0x3f0e39da,0x00000000,0x3e605c13,0x3edae880,0x3f1d7fd1
.long 0x00000000,0x3e78cfcc,0x3ef15aea,0x3f2beb4a,0x00000000,0x3e888e93,0x3f039c3d,0x3f396842
.long 0x00000000,0x3e94a031,0x3f0e39da,0x3f45e403,0x00000000,0x3ea09ae5,0x3f187fc0,0x3f514d3d
.long 0x00000000,0x3eac7cd4,0x3f226799,0x3f5b941a,0x00000000,0x3eb8442a,0x3f2beb4a,0x3f64aa59
.long 0x00000000,0x00000000,0x00000000,0x00000000,0x3dc8bd36,0x3dfab273,0x3e164083,0x3e2f10a2
.long 0x3e47c5c2,0x3e78cfcc,0x3e94a031,0x3eac7cd4,0x3e94a031,0x3eb8442a,0x3edae880,0x3efc5d27
.long 0x3ec3ef15,0x3ef15aea,0x3f0e39da,0x3f226799,0x3ef15aea,0x3f13682a,0x3f2beb4a,0x3f41d870
.long 0x3f0e39da,0x3f2beb4a,0x3f45e403,0x3f5b941a,0x3f226799,0x3f41d870,0x3f5b941a,0x3f6ed89e
.long 0x3f3504f3,0x3f54db31,0x3f6c835e,0x3f7b14be,0x3f45e403,0x3f64aa59,0x3f7853f8,0x3f7fec43
.long 0x3f54db31,0x3f710908,0x3f7ec46d,0x3f7d3aac,0x3f61c598,0x3f79c79d,0x3f7fb10f,0x3f731447
.long 0x3f6c835e,0x3f7ec46d,0x3f7b14be,0x3f61c598,0x3f74fa0b,0x3f7fec43,0x3f710908,0x3f49d112
.long 0x3f7b14be,0x3f7d3aac,0x3f61c598,0x3f2beb4a,0x3f7ec46d,0x3f76ba07,0x3f4d9f02,0x3f08f59b
.long 0x00000000,0x00000000,0x00000000,0x00000000,0x3e47c5c2,0x3e605c13,0x3e78cfcc,0x3e888e93
.long 0x3ec3ef15,0x3edae880,0x3ef15aea,0x3f039c3d,0x3f0e39da,0x3f1d7fd1,0x3f2beb4a,0x3f396842
.long 0x3f3504f3,0x3f45e403,0x3f54db31,0x3f61c598,0x3f54db31,0x3f64aa59,0x3f710908,0x3f79c79d
.long 0x3f6c835e,0x3f7853f8,0x3f7ec46d,0x3f7fb10f,0x3f7b14be,0x3f7fec43,0x3f7d3aac,0x3f731447
.long 0x3f800000,0x3f7b14be,0x3f6c835e,0x3f54db31,0x3f7b14be,0x3f6a09a7,0x3f4d9f02,0x3f273656
.long 0x3f6c835e,0x3f4d9f02,0x3f226799,0x3edae880,0x3f54db31,0x3f273656,0x3edae880,0x3e2f10a2
.long 0x3f3504f3,0x3ef15aea,0x3e47c5c2,0xbdc8bd36,0x3f0e39da,0x3e888e93,0xbd48fb30,0xbeb8442a
.long 0x3ec3ef15,0x3d48fb30,0xbe94a031,0xbf187fc0,0x3e47c5c2,0xbe2f10a2,0xbf039c3d,0xbf49d112
.long 0x00000000,0x00000000,0x00000000,0x00000000,0x3e94a031,0x3ea09ae5,0x3eac7cd4,0x3eb8442a
.long 0x3f0e39da,0x3f187fc0,0x3f226799,0x3f2beb4a,0x3f45e403,0x3f514d3d,0x3f5b941a,0x3f64aa59
.long 0x3f6c835e,0x3f74fa0b,0x3f7b14be,0x3f7ec46d,0x3f7ec46d,0x3f7fec43,0x3f7d3aac,0x3f76ba07
.long 0x3f7b14be,0x3f710908,0x3f61c598,0x3f4d9f02,0x3f61c598,0x3f49d112,0x3f2beb4a,0x3f08f59b
.long 0x3f3504f3,0x3f0e39da,0x3ec3ef15,0x3e47c5c2,0x3ef15aea,0x3e888e93,0x3d48fb30,0xbe2f10a2
.long 0x3e47c5c2,0xbd48fb30,0xbe94a031,0xbf039c3d,0xbdc8bd36,0xbeb8442a,0xbf187fc0,0xbf49d112
.long 0xbec3ef15,0xbf226799,0xbf54db31,0xbf74fa0b,0xbf226799,0xbf584853,0xbf7853f8,0xbf7f4e6d
.long 0xbf54db31,0xbf7853f8,0xbf7ec46d,0xbf676bd8,0xbf74fa0b,0xbf7f4e6d,0xbf676bd8,0xbf3085bb
.size L_tables, 26624
.fill (8192 - ((. - adaLN_cond__spectral_gfnet__moe_arch_mod__prompt_kernel) & 8191)) & 8191, 1, 0
L_tables_end:
.section .rodata,"a"
.p2align 6
.amdhsa_kernel adaLN_cond__spectral_gfnet__moe_arch_mod__prompt_kernel
  .amdhsa_next_free_vgpr 168
  .amdhsa_next_free_sgpr 102
  .amdhsa_accum_offset 168
  .amdhsa_group_segment_fixed_size 0
  .amdhsa_kernarg_size 104
  .amdhsa_user_sgpr_count 2
  .amdhsa_user_sgpr_kernarg_segment_ptr 1
  .amdhsa_system_sgpr_workgroup_id_x 1
.end_amdhsa_kernel
```
